```python
import torch

def _softmax(x, axis=-1):
    return torch.softmax(x, dim=axis)
def _gelu(x):
    return torch.nn.functional.gelu(x, approximate="tanh")
def _silu(x):
    return torch.nn.functional.silu(x)
def _sigmoid(x):
    return torch.sigmoid(x)
def _layernorm(x, axis=-1, eps=1e-5):
    m = x.mean(dim=axis, keepdim=True)
    v = x.var(dim=axis, keepdim=True, unbiased=False)
    return (x - m) / torch.sqrt(v + eps)
def _scatter_add(tgt, idx, src, axis=0):
    return tgt.clone().index_add_(axis, idx, src)
def _segment_sum(src, seg, n):
    out = torch.zeros((n,) + src.shape[1:], dtype=src.dtype)
    return out.index_add_(0, seg, src)
def _pad(x, pw):
    flat = tuple(v for pair in reversed(pw) for v in pair)
    return torch.nn.functional.pad(x, flat)

kernel_name = 'sequential_preLN__gqa_block_cached__geglu_ffn__decode'

def setup_inputs():

    _w = (lambda a: (lambda t: t.to(torch.bfloat16) if t.is_floating_point() else t)(torch.as_tensor(a)))
    def _A_setup():
        B, Sq, D = 2, 1, 576
        Hq, Hkv, Sk, Dh = 32, 16, 8192, 128
        assert Hq % Hkv == 0, (Hq, Hkv)
        return {
            "x": _w((lambda *s: torch.randn(*s, dtype=torch.bfloat16) * 0.05)(B, Sq, D)),
            "k_cache": _w((lambda *s: torch.randn(*s, dtype=torch.bfloat16) * 3.2)(B, Hkv, Sk, Dh)),
            "v_cache": _w((lambda *s: torch.randn(*s, dtype=torch.bfloat16) * 0.4)(B, Hkv, Sk, Dh)),
            "wq": _w((lambda *s: torch.randn(*s, dtype=torch.bfloat16) * 3.2)(D, Hq * Dh) * (D ** -0.5)),
            "wo": _w((lambda *s: torch.randn(*s, dtype=torch.bfloat16) * 0.4)(Hq * Dh, D) * ((Hq * Dh) ** -0.5)),
        }
    _A_in = _A_setup()

    def _B_setup():
        B, S, D, F = 2, 1, 576, 4608
        return {
            "x": _w((lambda *s: torch.randn(*s, dtype=torch.bfloat16) * 0.05)(B, S, D)),
            "w_gate": _w((lambda *s: torch.randn(*s, dtype=torch.bfloat16) * 0.05)(D, F)),
            "w_up": _w((lambda *s: torch.randn(*s, dtype=torch.bfloat16) * 0.05)(D, F)),
            "w_down": _w((lambda *s: torch.randn(*s, dtype=torch.bfloat16) * 0.05)(F, D)),
        }
    _B_in = _B_setup()

    return {
        "A_x": _A_in["x"],
        "A_k_cache": _A_in["k_cache"],
        "A_v_cache": _A_in["v_cache"],
        "A_wq": _A_in["wq"],
        "A_wo": _A_in["wo"],
        "B_x": _B_in["x"],
        "B_w_gate": _B_in["w_gate"],
        "B_w_up": _B_in["w_up"],
        "B_w_down": _B_in["w_down"],
    }

def reference(A_x, A_k_cache, A_v_cache, A_wq, A_wo, B_x, B_w_gate, B_w_up, B_w_down):
    def _A_ref(x, k_cache, v_cache, wq, wo):
        B, Sq, D = x.shape
        Hq, Dh = 32, 128
        Hkv = k_cache.shape[1]
        rep = Hq // Hkv
        q = (lambda x, *d: x.permute(*d))((x @ wq).reshape(B, Sq, Hq, Dh), 0, 2, 1, 3)
        k = (lambda x, n, axis: torch.repeat_interleave(x, n, dim=axis))(k_cache, rep, axis=1)
        v = (lambda x, n, axis: torch.repeat_interleave(x, n, dim=axis))(v_cache, rep, axis=1)
        scores = torch.einsum("bhqd,bhkd->bhqk", q, k) * (Dh ** -0.5)
        p = _softmax(scores, axis=-1)
        o = torch.einsum("bhqk,bhkd->bhqd", p, v)
        return (lambda x, *d: x.permute(*d))(o, 0, 2, 1, 3).reshape(B, Sq, Hq * Dh) @ wo

    def _B_ref(x, w_gate, w_up, w_down):
        return (_gelu(x @ w_gate) * (x @ w_up)) @ w_down

    x = A_x
    h = x + _A_ref(_layernorm(x, axis=-1), A_k_cache, A_v_cache, A_wq, A_wo)
    h2 = h + _B_ref(_layernorm(h, axis=-1), B_w_gate, B_w_up, B_w_down)
    return h2
```

```asm
; @launch grid=(256,1,1) block=(512,1,1) lds=135936
.amdgcn_target "amdgcn-amd-amdhsa--gfx950"
.text
.globl sequential_preLN__gqa_block_cached__geglu_ffn__decode_kernel
.p2align 8
.type sequential_preLN__gqa_block_cached__geglu_ffn__decode_kernel,@function
sequential_preLN__gqa_block_cached__geglu_ffn__decode_kernel:
    s_cmp_ge_u32 s2, 256
    s_cbranch_scc1 L_end
    s_load_dwordx16 s[64:79], s[0:1], 0
    s_load_dwordx8 s[80:87], s[0:1], 64
    v_and_b32 v1, 63, v0
    v_lshrrev_b32 v4, 6, v0
    s_nop 0
    v_readfirstlane_b32 s3, v4
    s_and_b32 s7, s2, 7
    s_lshr_b32 s63, s2, 3
    s_lshr_b32 s56, s7, 1
    s_and_b32 s57, s7, 1
    s_mul_i32 s58, s56, 36
    s_add_u32 s58, s58, s63
    s_lshl_b32 s59, s57, 5
    s_add_u32 s58, s58, s59
    s_sub_u32 s58, s58, 16
    s_lshl_b32 s59, s56, 4
    s_add_u32 s60, s59, s63
    s_cmp_eq_u32 s57, 0
    s_cbranch_scc1 L_even
    s_cmp_lt_u32 s63, 20
    s_cselect_b32 s5, 0, 2
    s_mov_b32 s6, s58
    s_sub_u32 s47, s60, 20
    s_cmp_lt_u32 s63, 20
    s_cselect_b32 s47, -1, s47
    s_branch L_roles
L_even:
    s_cmp_lt_u32 s63, 16
    s_cselect_b32 s5, 1, 0
    s_cselect_b32 s6, s60, s58
    s_sub_u32 s47, s60, 16
    s_cmp_lt_u32 s63, 28
    s_cselect_b32 s47, -1, s47
L_roles:
    s_mul_i32 s57, s3, 9216
    s_mov_b32 s27, 0x20000
    s_cmp_lt_i32 s47, 0
    s_cbranch_scc1 L_j1
    v_lshrrev_b32 v16, 3, v1
    v_lshlrev_b32 v16, 13, v16
    v_and_b32 v17, 7, v1
    v_lshl_add_u32 v16, v17, 4, v16
    s_mul_i32 s56, s3, 589824
    s_lshl_b32 s58, s47, 7
    s_add_u32 s56, s56, s58
    s_add_u32 s57, s57, 61952
    s_mov_b32 s58, 65536
    s_mov_b32 s26, 4718592
    v_lshlrev_b32 v10, 2, v1
    v_mov_b32 v128, 0
    v_mov_b32 v130, 0
    s_waitcnt lgkmcnt(0)
    s_mov_b32 s24, s70
    s_mov_b32 s25, s71
    s_cmp_lg_u32 s3, 0
    s_cbranch_scc1 L_jgo
    s_mov_b32 s20, s64
    s_mov_b32 s21, s65
    s_mov_b32 s22, 2304
    s_mov_b32 s23, 0x20000
    buffer_load_dword v112, v10, s[20:23], 0 offen offset:0
    buffer_load_dword v114, v10, s[20:23], 0 offen offset:1152
    buffer_load_dword v116, v10, s[20:23], 0 offen offset:256
    buffer_load_dword v118, v10, s[20:23], 0 offen offset:1408
    buffer_load_dword v120, v10, s[20:23], 0 offen offset:512
    buffer_load_dword v122, v10, s[20:23], 0 offen offset:1664
    buffer_load_dword v124, v10, s[20:23], 0 offen offset:768
    buffer_load_dword v126, v10, s[20:23], 0 offen offset:1920
    s_mov_b32 exec_hi, 0
    buffer_load_dword v128, v10, s[20:23], 0 offen offset:1024
    buffer_load_dword v130, v10, s[20:23], 0 offen offset:2176
    s_mov_b64 exec, -1
    s_branch L_jgo
L_j1:
    s_cmp_eq_u32 s5, 0
    s_cbranch_scc1 L_j2
    v_lshlrev_b32 v16, 4, v1
    s_mul_i32 s56, s6, 73728
    s_add_u32 s56, s56, s57
    s_add_u32 s57, s57, 25088
    s_mov_b32 s58, 1024
    s_mov_b32 s26, 4718592
    s_waitcnt lgkmcnt(0)
    s_mov_b32 s24, s72
    s_mov_b32 s25, s73
    s_branch L_jgo
L_j2:
    v_lshrrev_b32 v16, 2, v1
    v_mul_u32_u24 v16, 9216, v16
    v_and_b32 v17, 3, v1
    v_lshrrev_b32 v18, 5, v1
    v_xor_b32 v17, v17, v18
    v_lshl_add_u32 v16, v17, 4, v16
    s_mul_i32 s56, s3, 1327104
    s_lshl_b32 s58, s6, 6
    s_add_u32 s56, s56, s58
    s_add_u32 s57, s57, 25088
    s_mov_b32 s58, 147456
    s_mov_b32 s26, 5308416
    s_waitcnt lgkmcnt(0)
    s_mov_b32 s24, s76
    s_mov_b32 s25, s77
    s_cmp_ge_u32 s3, 4
    s_cbranch_scc1 L_jdone
L_jgo:
    s_mov_b32 m0, s57
    s_nop 0
    buffer_load_dwordx4 v16, s[24:27], s56 offen nt lds
    s_add_u32 s56, s56, s58
    s_add_u32 s57, s57, 1024
    s_mov_b32 m0, s57
    s_nop 0
    buffer_load_dwordx4 v16, s[24:27], s56 offen nt lds
    s_add_u32 s56, s56, s58
    s_add_u32 s57, s57, 1024
    s_mov_b32 m0, s57
    s_nop 0
    buffer_load_dwordx4 v16, s[24:27], s56 offen nt lds
    s_add_u32 s56, s56, s58
    s_add_u32 s57, s57, 1024
    s_mov_b32 m0, s57
    s_nop 0
    buffer_load_dwordx4 v16, s[24:27], s56 offen nt lds
    s_add_u32 s56, s56, s58
    s_add_u32 s57, s57, 1024
    s_mov_b32 m0, s57
    s_nop 0
    buffer_load_dwordx4 v16, s[24:27], s56 offen nt lds
    s_add_u32 s56, s56, s58
    s_add_u32 s57, s57, 1024
    s_mov_b32 m0, s57
    s_nop 0
    buffer_load_dwordx4 v16, s[24:27], s56 offen nt lds
    s_add_u32 s56, s56, s58
    s_add_u32 s57, s57, 1024
    s_mov_b32 m0, s57
    s_nop 0
    buffer_load_dwordx4 v16, s[24:27], s56 offen nt lds
    s_add_u32 s56, s56, s58
    s_add_u32 s57, s57, 1024
    s_mov_b32 m0, s57
    s_nop 0
    buffer_load_dwordx4 v16, s[24:27], s56 offen nt lds
    s_add_u32 s56, s56, s58
    s_add_u32 s57, s57, 1024
    s_mov_b32 m0, s57
    s_nop 0
    buffer_load_dwordx4 v16, s[24:27], s56 offen nt lds
L_jdone:
    v_mov_b32 v8, 0
    v_mov_b32 v9, 0
    v_mov_b32 v10, 0
    v_mov_b32 v11, 0
    ds_write_b128 v8, v[8:11] offset:128
    ds_write_b128 v8, v[8:11] offset:144
    s_mov_b32 s48, 4096
    s_mov_b32 s8, 0xbdccb5bd
    s_mov_b32 s9, 0xbdccb5cc
    s_mov_b32 s10, 0xbdccbdc4
    s_mov_b32 s11, 0xcd7dcec5
    s_mov_b32 s12, 0xcdcdce75
    s_mov_b32 s13, 0x7dcdcec5
    s_mov_b32 s14, 0xbcbc5dbd
    s_mov_b32 s15, 0xcdc56ece
    s_mov_b32 s16, 0xbcb4cdcd
    s_mov_b32 s17, 0xcdc0cdce
    s_mov_b32 s18, 0xcdc0cdce
    s_mov_b32 s19, 0xbc7d7dcd
    s_mov_b32 s20, 0xbcacbd6d
    s_mov_b32 s21, 0x77bdcdbe
    s_mov_b32 s22, 0xa6bdbdbd
    s_mov_b32 s23, 0xb4bdcdbd
    s_mov_b32 s24, 0xb4bdcdbd
    s_mov_b32 s25, 0xb4bdcdbd
    s_mov_b32 s26, 0xb5bdccbd
    s_mov_b32 s27, 0xbdbe7d5e
    s_mov_b32 s28, 0xbebec75e
    s_mov_b32 s29, 0xadbdb6bd
    s_mov_b32 s30, 0xbdbd5cbc
    s_mov_b32 s31, 0xbdbd5cbc
    s_mov_b32 s32, 0x5dbdbcbc
    s_mov_b32 s33, 0x5dbdbcbc
    s_mov_b32 s34, 0xbd5dbcbc
    s_mov_b32 s35, 0xbd5cbcbd
    s_mov_b32 s36, 0xbdbcbdb6
    s_mov_b32 s37, 0xbdbcbdb6
    s_mov_b32 s38, 0xbdbdb5bd
    s_mov_b32 s39, 0xbdbdb5bd
    s_mov_b32 s58, 0x14020d06
    s_mov_b32 s59, 0xe130c0b
    s_lshl_b32 s60, s7, 3
    s_lshr_b64 s[58:59], s[58:59], s60
    s_add_u32 s44, s58, s63
    s_and_b32 s44, s44, 31
    s_mov_b32 s46, s7
    s_mov_b32 m0, s44
    s_mov_b32 s7, s46
    s_movrels_b32 s58, s8
    s_lshr_b32 s45, s44, 4
    s_and_b32 s44, s44, 15
    s_lshl_b32 s60, s7, 2
    s_lshr_b32 s50, s58, s60
    s_and_b32 s50, s50, 15
    s_add_u32 s50, s50, 21
    s_bfm_b32 s59, s60, 0
    s_and_b32 s58, s58, s59
    s_lshr_b32 s59, s58, 4
    s_and_b32 s58, s58, 0x0f0f0f0f
    s_and_b32 s59, s59, 0x0f0f0f0f
    s_add_u32 s58, s58, s59
    s_mul_i32 s58, s58, 0x01010101
    s_lshr_b32 s58, s58, 24
    s_mul_i32 s59, s7, 21
    s_add_u32 s58, s58, s59
    s_lshl_b32 s58, s58, 13
    s_lshl_b32 s51, s50, 12
    s_lshr_b32 s60, s3, 2
    s_mul_i32 s59, s51, s60
    s_add_u32 s58, s58, s59
    s_and_b32 s62, s3, 3
    s_lshl_b32 s62, s62, 10
    v_lshrrev_b32 v5, 4, v1
    v_and_b32 v6, 15, v1
    v_lshlrev_b32 v2, 6, v5
    v_bfe_u32 v7, v1, 2, 2
    v_lshl_add_u32 v2, v7, 8, v2
    v_and_b32 v7, 3, v1
    v_lshl_add_u32 v2, v7, 4, v2
    v_lshlrev_b32 v3, 4, v1
    s_lshl_b32 s56, s45, 4
    s_add_u32 s56, s56, s44
    s_lshl_b32 s61, s56, 10
    s_lshl_b32 s56, s56, 21
    s_add_u32 s56, s56, s58
    s_add_u32 s51, s51, s56
    s_add_u32 s56, s56, s62
    v_add_u32 v2, s56, v2
    v_add_u32 v3, s56, v3
    v_add_u32 v3, 143360, v3
    s_cmp_eq_u32 s5, 1
    s_cselect_b32 s28, s72, s76
    s_cselect_b32 s29, s73, s77
    s_mov_b32 s30, 5308416
    s_cselect_b32 s30, 4718592, s30
    s_mov_b32 s31, 0x20000
    s_mov_b32 s8, s66
    s_mov_b32 s9, s67
    s_mov_b32 s10, s51
    s_mov_b32 s11, 0x20000
    s_mov_b32 s12, s68
    s_mov_b32 s13, s69
    s_mov_b32 s14, s51
    s_mov_b32 s15, 0x20000
    s_mov_b32 s16, s86
    s_mov_b32 s17, s87
    s_mov_b32 s18, 268435456
    s_mov_b32 s19, 0x20000
    s_mov_b32 s20, s64
    s_mov_b32 s21, s65
    s_mov_b32 s22, 2304
    s_mov_b32 s23, 0x20000
    s_load_dword s4, s[16:17], 0
    s_mov_b32 s32, s78
    s_mov_b32 s33, s79
    s_mov_b32 s34, 5308416
    s_mov_b32 s35, 0x20000
    s_mov_b32 s36, s80
    s_mov_b32 s37, s81
    s_mov_b32 s38, 5308416
    s_mov_b32 s39, 0x20000
    s_mov_b32 s40, s82
    s_mov_b32 s41, s83
    s_mov_b32 s42, 2304
    s_mov_b32 s43, 0x20000
    v_and_b32 v7, 3, v1
    v_lshlrev_b32 v8, 4, v1
    s_add_u32 s61, s61, 4096
    s_waitcnt lgkmcnt(0)
    s_add_u32 s4, s4, 1
    s_barrier
    s_cmp_lt_i32 s47, 0
    s_cbranch_scc1 L_noq
    v_lshlrev_b32 v13, 2, v1
    v_add_u32 v13, 768, v13
    v_and_b32 v15, 1, v1
    v_mul_u32_u24 v15, 1344, v15
    v_lshl_add_u32 v15, v5, 4, v15
    v_add_u32 v15, 768, v15
    s_cmp_lg_u32 s3, 0
    s_cbranch_scc1 L_q_noln
    s_waitcnt vmcnt(9)
    v_lshlrev_b32 v136, 16, v112
    v_and_b32 v137, 0xffff0000, v112
    v_lshlrev_b32 v138, 16, v114
    v_and_b32 v139, 0xffff0000, v114
    v_lshlrev_b32 v140, 16, v116
    v_and_b32 v141, 0xffff0000, v116
    v_lshlrev_b32 v142, 16, v118
    v_and_b32 v143, 0xffff0000, v118
    v_lshlrev_b32 v144, 16, v120
    v_and_b32 v145, 0xffff0000, v120
    v_lshlrev_b32 v146, 16, v122
    v_and_b32 v147, 0xffff0000, v122
    v_lshlrev_b32 v148, 16, v124
    v_and_b32 v149, 0xffff0000, v124
    v_lshlrev_b32 v150, 16, v126
    v_and_b32 v151, 0xffff0000, v126
    v_lshlrev_b32 v152, 16, v128
    v_and_b32 v153, 0xffff0000, v128
    v_lshlrev_b32 v154, 16, v130
    v_and_b32 v155, 0xffff0000, v130
    v_add_f32 v156, v136, v137
    v_mul_f32 v158, v136, v136
    v_add_f32 v157, v138, v139
    v_mul_f32 v159, v138, v138
    v_fmac_f32 v158, v137, v137
    v_fmac_f32 v159, v139, v139
    v_add_f32 v156, v156, v140
    v_fmac_f32 v158, v140, v140
    v_add_f32 v157, v157, v142
    v_fmac_f32 v159, v142, v142
    v_add_f32 v156, v156, v141
    v_fmac_f32 v158, v141, v141
    v_add_f32 v157, v157, v143
    v_fmac_f32 v159, v143, v143
    v_add_f32 v156, v156, v144
    v_fmac_f32 v158, v144, v144
    v_add_f32 v157, v157, v146
    v_fmac_f32 v159, v146, v146
    v_add_f32 v156, v156, v145
    v_fmac_f32 v158, v145, v145
    v_add_f32 v157, v157, v147
    v_fmac_f32 v159, v147, v147
    v_add_f32 v156, v156, v148
    v_fmac_f32 v158, v148, v148
    v_add_f32 v157, v157, v150
    v_fmac_f32 v159, v150, v150
    v_add_f32 v156, v156, v149
    v_fmac_f32 v158, v149, v149
    v_add_f32 v157, v157, v151
    v_fmac_f32 v159, v151, v151
    v_add_f32 v156, v156, v152
    v_fmac_f32 v158, v152, v152
    v_add_f32 v157, v157, v154
    v_fmac_f32 v159, v154, v154
    v_add_f32 v156, v156, v153
    v_fmac_f32 v158, v153, v153
    v_add_f32 v157, v157, v155
    v_fmac_f32 v159, v155, v155
    v_add_f32_dpp v156, v156, v156 row_ror:8 row_mask:0xf bank_mask:0xf
    v_add_f32_dpp v157, v157, v157 row_ror:8 row_mask:0xf bank_mask:0xf
    v_add_f32_dpp v158, v158, v158 row_ror:8 row_mask:0xf bank_mask:0xf
    v_add_f32_dpp v159, v159, v159 row_ror:8 row_mask:0xf bank_mask:0xf
    v_add_f32_dpp v156, v156, v156 row_ror:4 row_mask:0xf bank_mask:0xf
    v_add_f32_dpp v157, v157, v157 row_ror:4 row_mask:0xf bank_mask:0xf
    v_add_f32_dpp v158, v158, v158 row_ror:4 row_mask:0xf bank_mask:0xf
    v_add_f32_dpp v159, v159, v159 row_ror:4 row_mask:0xf bank_mask:0xf
    v_add_f32_dpp v156, v156, v156 row_ror:2 row_mask:0xf bank_mask:0xf
    v_add_f32_dpp v157, v157, v157 row_ror:2 row_mask:0xf bank_mask:0xf
    v_add_f32_dpp v158, v158, v158 row_ror:2 row_mask:0xf bank_mask:0xf
    v_add_f32_dpp v159, v159, v159 row_ror:2 row_mask:0xf bank_mask:0xf
    v_add_f32_dpp v156, v156, v156 row_ror:1 row_mask:0xf bank_mask:0xf
    v_add_f32_dpp v157, v157, v157 row_ror:1 row_mask:0xf bank_mask:0xf
    v_add_f32_dpp v158, v158, v158 row_ror:1 row_mask:0xf bank_mask:0xf
    v_add_f32_dpp v159, v159, v159 row_ror:1 row_mask:0xf bank_mask:0xf
    v_add_f32_dpp v156, v156, v156 row_bcast:15 row_mask:0xa bank_mask:0xf
    v_add_f32_dpp v157, v157, v157 row_bcast:15 row_mask:0xa bank_mask:0xf
    v_add_f32_dpp v158, v158, v158 row_bcast:15 row_mask:0xa bank_mask:0xf
    v_add_f32_dpp v159, v159, v159 row_bcast:15 row_mask:0xa bank_mask:0xf
    v_add_f32_dpp v156, v156, v156 row_bcast:31 row_mask:0xc bank_mask:0xf
    v_add_f32_dpp v157, v157, v157 row_bcast:31 row_mask:0xc bank_mask:0xf
    v_add_f32_dpp v158, v158, v158 row_bcast:31 row_mask:0xc bank_mask:0xf
    v_add_f32_dpp v159, v159, v159 row_bcast:31 row_mask:0xc bank_mask:0xf
    v_readlane_b32 s64, v156, 63
    v_readlane_b32 s65, v157, 63
    v_readlane_b32 s66, v158, 63
    v_readlane_b32 s67, v159, 63
    v_mov_b32 v164, 0x3ae38e39
    v_mul_f32 v160, s64, v164
    v_mul_f32 v161, s65, v164
    v_mul_f32 v162, s66, v164
    v_mul_f32 v163, s67, v164
    v_fma_f32 v162, -v160, v160, v162
    v_fma_f32 v163, -v161, v161, v163
    v_max_f32 v162, 0, v162
    v_max_f32 v163, 0, v163
    v_cvt_pk_bf16_f32 v164, v160, v161
    v_cvt_pk_bf16_f32 v165, v162, v163
    v_lshlrev_b32 v160, 16, v164
    v_and_b32 v161, 0xffff0000, v164
    v_lshlrev_b32 v162, 16, v165
    v_and_b32 v163, 0xffff0000, v165
    v_add_f32 v162, 0x3727c5ac, v162
    v_add_f32 v163, 0x3727c5ac, v163
    v_cvt_pk_bf16_f32 v165, v162, v163
    v_lshlrev_b32 v162, 16, v165
    v_and_b32 v163, 0xffff0000, v165
    v_sqrt_f32 v162, v162
    v_sqrt_f32 v163, v163
    v_sub_f32 v136, v136, v160
    v_sub_f32 v137, v137, v160
    v_sub_f32 v138, v138, v161
    v_sub_f32 v139, v139, v161
    v_sub_f32 v140, v140, v160
    v_sub_f32 v141, v141, v160
    v_sub_f32 v142, v142, v161
    v_sub_f32 v143, v143, v161
    v_sub_f32 v144, v144, v160
    v_sub_f32 v145, v145, v160
    v_sub_f32 v146, v146, v161
    v_sub_f32 v147, v147, v161
    v_sub_f32 v148, v148, v160
    v_sub_f32 v149, v149, v160
    v_sub_f32 v150, v150, v161
    v_sub_f32 v151, v151, v161
    v_sub_f32 v152, v152, v160
    v_sub_f32 v153, v153, v160
    v_sub_f32 v154, v154, v161
    v_sub_f32 v155, v155, v161
    v_cvt_pk_bf16_f32 v165, v162, v163
    v_lshlrev_b32 v162, 16, v165
    v_and_b32 v163, 0xffff0000, v165
    v_rcp_f32 v162, v162
    v_rcp_f32 v163, v163
    v_cvt_pk_bf16_f32 v136, v136, v137
    v_cvt_pk_bf16_f32 v138, v138, v139
    v_cvt_pk_bf16_f32 v140, v140, v141
    v_cvt_pk_bf16_f32 v142, v142, v143
    v_cvt_pk_bf16_f32 v144, v144, v145
    v_cvt_pk_bf16_f32 v146, v146, v147
    v_cvt_pk_bf16_f32 v148, v148, v149
    v_cvt_pk_bf16_f32 v150, v150, v151
    v_cvt_pk_bf16_f32 v152, v152, v153
    v_cvt_pk_bf16_f32 v154, v154, v155
    v_and_b32 v137, 0xffff0000, v136
    v_lshlrev_b32 v136, 16, v136
    v_mul_f32 v137, v137, v162
    v_mul_f32 v136, v136, v162
    v_cvt_pk_bf16_f32 v136, v136, v137
    ds_write_b32 v13, v136 offset:0
    v_and_b32 v139, 0xffff0000, v138
    v_lshlrev_b32 v138, 16, v138
    v_mul_f32 v139, v139, v163
    v_mul_f32 v138, v138, v163
    v_cvt_pk_bf16_f32 v138, v138, v139
    ds_write_b32 v13, v138 offset:1344
    v_and_b32 v141, 0xffff0000, v140
    v_lshlrev_b32 v140, 16, v140
    v_mul_f32 v141, v141, v162
    v_mul_f32 v140, v140, v162
    v_cvt_pk_bf16_f32 v140, v140, v141
    ds_write_b32 v13, v140 offset:256
    v_and_b32 v143, 0xffff0000, v142
    v_lshlrev_b32 v142, 16, v142
    v_mul_f32 v143, v143, v163
    v_mul_f32 v142, v142, v163
    v_cvt_pk_bf16_f32 v142, v142, v143
    ds_write_b32 v13, v142 offset:1600
    v_and_b32 v145, 0xffff0000, v144
    v_lshlrev_b32 v144, 16, v144
    v_mul_f32 v145, v145, v162
    v_mul_f32 v144, v144, v162
    v_cvt_pk_bf16_f32 v144, v144, v145
    ds_write_b32 v13, v144 offset:512
    v_and_b32 v147, 0xffff0000, v146
    v_lshlrev_b32 v146, 16, v146
    v_mul_f32 v147, v147, v163
    v_mul_f32 v146, v146, v163
    v_cvt_pk_bf16_f32 v146, v146, v147
    ds_write_b32 v13, v146 offset:1856
    v_and_b32 v149, 0xffff0000, v148
    v_lshlrev_b32 v148, 16, v148
    v_mul_f32 v149, v149, v162
    v_mul_f32 v148, v148, v162
    v_cvt_pk_bf16_f32 v148, v148, v149
    ds_write_b32 v13, v148 offset:768
    v_and_b32 v151, 0xffff0000, v150
    v_lshlrev_b32 v150, 16, v150
    v_mul_f32 v151, v151, v163
    v_mul_f32 v150, v150, v163
    v_cvt_pk_bf16_f32 v150, v150, v151
    ds_write_b32 v13, v150 offset:2112
    v_and_b32 v153, 0xffff0000, v152
    v_lshlrev_b32 v152, 16, v152
    v_mul_f32 v153, v153, v162
    v_mul_f32 v152, v152, v162
    v_cvt_pk_bf16_f32 v152, v152, v153
    ds_write_b32 v13, v152 offset:1024
    v_and_b32 v155, 0xffff0000, v154
    v_lshlrev_b32 v154, 16, v154
    v_mul_f32 v155, v155, v163
    v_mul_f32 v154, v154, v163
    v_cvt_pk_bf16_f32 v154, v154, v155
    ds_write_b32 v13, v154 offset:2368
L_q_noln:
    buffer_load_dwordx4 v[64:67], v2, s[8:11], 0 offen nt
    v_add_u32 v2, s48, v2
    buffer_load_dwordx4 v[68:71], v2, s[8:11], 0 offen nt
    v_add_u32 v2, s48, v2
    buffer_load_dwordx4 v[72:75], v2, s[8:11], 0 offen nt
    v_add_u32 v2, s48, v2
    buffer_load_dwordx4 v[76:79], v2, s[8:11], 0 offen nt
    v_add_u32 v2, s48, v2
    buffer_load_dwordx4 v[80:83], v2, s[8:11], 0 offen nt
    v_add_u32 v2, s48, v2
    s_waitcnt vmcnt(5) lgkmcnt(0)
    s_barrier
    s_cmp_lt_u32 s3, 4
    s_cbranch_scc1 L_q_mm
    s_waitcnt vmcnt(9)
    buffer_load_dwordx4 v[84:87], v2, s[8:11], 0 offen nt
    v_add_u32 v2, s48, v2
    s_waitcnt vmcnt(9)
    buffer_load_dwordx4 v[88:91], v2, s[8:11], 0 offen nt
    v_add_u32 v2, s48, v2
    s_waitcnt vmcnt(9)
    buffer_load_dwordx4 v[92:95], v2, s[8:11], 0 offen nt
    v_add_u32 v2, s48, v2
    s_waitcnt vmcnt(9)
    buffer_load_dwordx4 v[96:99], v2, s[8:11], 0 offen nt
    v_add_u32 v2, s48, v2
    s_waitcnt vmcnt(9)
    buffer_load_dwordx4 v[100:103], v2, s[8:11], 0 offen nt
    v_add_u32 v2, s48, v2
    s_waitcnt vmcnt(9)
    buffer_load_dwordx4 v[104:107], v2, s[8:11], 0 offen nt
    v_add_u32 v2, s48, v2
    s_waitcnt vmcnt(9)
    buffer_load_dwordx4 v[108:111], v2, s[8:11], 0 offen nt
    v_add_u32 v2, s48, v2
    s_waitcnt vmcnt(9)
    buffer_load_dwordx4 v[112:115], v2, s[8:11], 0 offen nt
    v_add_u32 v2, s48, v2
    s_waitcnt vmcnt(9)
    buffer_load_dwordx4 v[116:119], v2, s[8:11], 0 offen nt
    v_add_u32 v2, s48, v2
    s_waitcnt vmcnt(9)
    buffer_load_dwordx4 v[120:123], v2, s[8:11], 0 offen nt
    v_add_u32 v2, s48, v2
    s_waitcnt vmcnt(9)
    buffer_load_dwordx4 v[124:127], v2, s[8:11], 0 offen nt
    v_add_u32 v2, s48, v2
    s_waitcnt vmcnt(9)
    buffer_load_dwordx4 v[128:131], v2, s[8:11], 0 offen nt
    v_add_u32 v2, s48, v2
    s_waitcnt vmcnt(9)
    buffer_load_dwordx4 v[132:135], v2, s[8:11], 0 offen nt
    v_add_u32 v2, s48, v2
    s_waitcnt vmcnt(9)
    buffer_load_dwordx4 v[136:139], v2, s[8:11], 0 offen nt
    v_add_u32 v2, s48, v2
    s_waitcnt vmcnt(9)
    buffer_load_dwordx4 v[140:143], v2, s[8:11], 0 offen nt
    v_add_u32 v2, s48, v2
    s_waitcnt vmcnt(9)
    buffer_load_dwordx4 v[144:147], v2, s[8:11], 0 offen nt
    v_add_u32 v2, s48, v2
    s_branch L_k_mid
L_q_mm:
    v_lshrrev_b32 v14, 2, v6
    v_lshl_add_u32 v14, v5, 3, v14
    v_lshlrev_b32 v14, 7, v14
    v_and_b32 v17, 3, v1
    v_lshl_add_u32 v14, v17, 3, v14
    s_lshl_b32 s7, s3, 5
    s_add_u32 s7, s7, 61952
    v_add_u32 v14, s7, v14
    v_add_u32 v17, 0x9000, v14
    ds_read_b64_tr_b16 v[184:185], v14 offset:0
    ds_read_b64_tr_b16 v[186:187], v14 offset:512
    ds_read_b64_tr_b16 v[188:189], v14 offset:4096
    ds_read_b64_tr_b16 v[190:191], v14 offset:4608
    ds_read_b64_tr_b16 v[192:193], v14 offset:8192
    ds_read_b64_tr_b16 v[194:195], v14 offset:8704
    ds_read_b64_tr_b16 v[196:197], v14 offset:12288
    ds_read_b64_tr_b16 v[198:199], v14 offset:12800
    ds_read_b64_tr_b16 v[200:201], v14 offset:16384
    ds_read_b64_tr_b16 v[202:203], v14 offset:16896
    ds_read_b64_tr_b16 v[204:205], v14 offset:20480
    ds_read_b64_tr_b16 v[206:207], v14 offset:20992
    ds_read_b64_tr_b16 v[208:209], v14 offset:24576
    ds_read_b64_tr_b16 v[210:211], v14 offset:25088
    ds_read_b64_tr_b16 v[212:213], v14 offset:28672
    ds_read_b64_tr_b16 v[214:215], v14 offset:29184
    ds_read_b64_tr_b16 v[216:217], v14 offset:32768
    ds_read_b64_tr_b16 v[218:219], v14 offset:33280
    ds_read_b64_tr_b16 v[220:221], v17 offset:0
    ds_read_b64_tr_b16 v[222:223], v17 offset:512
    ds_read_b64_tr_b16 v[224:225], v17 offset:4096
    ds_read_b64_tr_b16 v[226:227], v17 offset:4608
    ds_read_b64_tr_b16 v[228:229], v17 offset:8192
    ds_read_b64_tr_b16 v[230:231], v17 offset:8704
    ds_read_b64_tr_b16 v[232:233], v17 offset:12288
    ds_read_b64_tr_b16 v[234:235], v17 offset:12800
    ds_read_b64_tr_b16 v[236:237], v17 offset:16384
    ds_read_b64_tr_b16 v[238:239], v17 offset:16896
    ds_read_b64_tr_b16 v[240:241], v17 offset:20480
    ds_read_b64_tr_b16 v[242:243], v17 offset:20992
    ds_read_b64_tr_b16 v[244:245], v17 offset:24576
    ds_read_b64_tr_b16 v[246:247], v17 offset:25088
    ds_read_b64_tr_b16 v[248:249], v17 offset:28672
    ds_read_b64_tr_b16 v[250:251], v17 offset:29184
    ds_read_b64_tr_b16 v[252:253], v17 offset:32768
    ds_read_b64_tr_b16 v[254:255], v17 offset:33280
    ds_read_b128 v[112:115], v15 offset:0
    ds_read_b128 v[116:119], v15 offset:64
    ds_read_b128 v[120:123], v15 offset:128
    ds_read_b128 v[124:127], v15 offset:192
    ds_read_b128 v[128:131], v15 offset:256
    ds_read_b128 v[132:135], v15 offset:320
    ds_read_b128 v[136:139], v15 offset:384
    ds_read_b128 v[140:143], v15 offset:448
    ds_read_b128 v[144:147], v15 offset:512
    ds_read_b128 v[148:151], v15 offset:576
    ds_read_b128 v[152:155], v15 offset:640
    ds_read_b128 v[156:159], v15 offset:704
    ds_read_b128 v[160:163], v15 offset:768
    ds_read_b128 v[164:167], v15 offset:832
    ds_read_b128 v[168:171], v15 offset:896
    ds_read_b128 v[172:175], v15 offset:960
    ds_read_b128 v[176:179], v15 offset:1024
    ds_read_b128 v[180:183], v15 offset:1088
    s_waitcnt lgkmcnt(15)
    v_mfma_f32_16x16x32_bf16 v[40:43], v[112:115], v[184:187], 0
    s_waitcnt lgkmcnt(15)
    v_mfma_f32_16x16x32_bf16 v[40:43], v[116:119], v[188:191], v[40:43]
    s_waitcnt lgkmcnt(15)
    v_mfma_f32_16x16x32_bf16 v[40:43], v[120:123], v[192:195], v[40:43]
    s_waitcnt lgkmcnt(14)
    v_mfma_f32_16x16x32_bf16 v[40:43], v[124:127], v[196:199], v[40:43]
    s_waitcnt lgkmcnt(13)
    v_mfma_f32_16x16x32_bf16 v[40:43], v[128:131], v[200:203], v[40:43]
    s_waitcnt lgkmcnt(12)
    v_mfma_f32_16x16x32_bf16 v[40:43], v[132:135], v[204:207], v[40:43]
    s_waitcnt lgkmcnt(11)
    v_mfma_f32_16x16x32_bf16 v[40:43], v[136:139], v[208:211], v[40:43]
    s_waitcnt lgkmcnt(10)
    v_mfma_f32_16x16x32_bf16 v[40:43], v[140:143], v[212:215], v[40:43]
    s_waitcnt lgkmcnt(9)
    v_mfma_f32_16x16x32_bf16 v[40:43], v[144:147], v[216:219], v[40:43]
    s_waitcnt lgkmcnt(8)
    v_mfma_f32_16x16x32_bf16 v[40:43], v[148:151], v[220:223], v[40:43]
    s_waitcnt lgkmcnt(7)
    v_mfma_f32_16x16x32_bf16 v[40:43], v[152:155], v[224:227], v[40:43]
    s_waitcnt lgkmcnt(6)
    v_mfma_f32_16x16x32_bf16 v[40:43], v[156:159], v[228:231], v[40:43]
    s_waitcnt lgkmcnt(5)
    v_mfma_f32_16x16x32_bf16 v[40:43], v[160:163], v[232:235], v[40:43]
    s_waitcnt lgkmcnt(4)
    v_mfma_f32_16x16x32_bf16 v[40:43], v[164:167], v[236:239], v[40:43]
    s_waitcnt lgkmcnt(3)
    v_mfma_f32_16x16x32_bf16 v[40:43], v[168:171], v[240:243], v[40:43]
    s_waitcnt lgkmcnt(2)
    v_mfma_f32_16x16x32_bf16 v[40:43], v[172:175], v[244:247], v[40:43]
    s_waitcnt lgkmcnt(1)
    v_mfma_f32_16x16x32_bf16 v[40:43], v[176:179], v[248:251], v[40:43]
    s_waitcnt lgkmcnt(0)
    v_mfma_f32_16x16x32_bf16 v[40:43], v[180:183], v[252:255], v[40:43]
    v_and_b32 v16, 16, v1
    v_cmp_ne_u32 vcc, 0, v16
    s_nop 5
    v_cndmask_b32 v44, v40, v41, vcc
    s_nop 1
    v_mov_b32_dpp v45, v44 quad_perm:[1,0,3,2] row_mask:0xf bank_mask:0xf
    v_cvt_pk_bf16_f32 v44, v44, v45
    s_nop 1
    v_mov_b32_dpp v46, v44 quad_perm:[2,2,2,2] row_mask:0xf bank_mask:0xf
    v_mov_b32 v45, s4
    v_mov_b32 v47, s4
    v_lshlrev_b32 v16, 10, v16
    v_lshl_add_u32 v16, v6, 2, v16
    s_lshl_b32 s56, s47, 8
    s_lshl_b32 s57, s3, 6
    s_add_u32 s56, s56, s57
    s_add_u32 s56, s56, 4096
    s_mov_b64 exec, 0x11111111
    buffer_store_dwordx4 v[44:47], v16, s[16:19], s56 offen sc1
    s_mov_b64 exec, -1
    s_cmp_lg_u32 s5, 0
    s_cbranch_scc1 L_kstream
    v_lshrrev_b32 v16, 2, v1
    v_mul_u32_u24 v16, 9216, v16
    v_and_b32 v17, 3, v1
    v_lshrrev_b32 v18, 5, v1
    v_xor_b32 v17, v17, v18
    v_lshl_add_u32 v16, v17, 4, v16
    s_mul_i32 s56, s3, 1327104
    s_lshl_b32 s7, s6, 6
    s_add_u32 s56, s56, s7
    s_mul_i32 s57, s3, 9216
    s_add_u32 s57, s57, 25088
    s_mov_b32 m0, s57
    s_nop 0
    buffer_load_dwordx4 v16, s[28:31], s56 offen nt lds
    s_add_u32 s56, s56, 147456
    s_add_u32 s57, s57, 1024
    s_mov_b32 m0, s57
    s_nop 0
    buffer_load_dwordx4 v16, s[28:31], s56 offen nt lds
    s_add_u32 s56, s56, 147456
    s_add_u32 s57, s57, 1024
    s_mov_b32 m0, s57
    s_nop 0
    buffer_load_dwordx4 v16, s[28:31], s56 offen nt lds
    s_add_u32 s56, s56, 147456
    s_add_u32 s57, s57, 1024
    s_mov_b32 m0, s57
    s_nop 0
    buffer_load_dwordx4 v16, s[28:31], s56 offen nt lds
    s_add_u32 s56, s56, 147456
    s_add_u32 s57, s57, 1024
    s_mov_b32 m0, s57
    s_nop 0
    buffer_load_dwordx4 v16, s[28:31], s56 offen nt lds
    s_add_u32 s56, s56, 147456
    s_add_u32 s57, s57, 1024
    s_mov_b32 m0, s57
    s_nop 0
    buffer_load_dwordx4 v16, s[28:31], s56 offen nt lds
    s_add_u32 s56, s56, 147456
    s_add_u32 s57, s57, 1024
    s_mov_b32 m0, s57
    s_nop 0
    buffer_load_dwordx4 v16, s[28:31], s56 offen nt lds
    s_add_u32 s56, s56, 147456
    s_add_u32 s57, s57, 1024
    s_mov_b32 m0, s57
    s_nop 0
    buffer_load_dwordx4 v16, s[28:31], s56 offen nt lds
    s_add_u32 s56, s56, 147456
    s_add_u32 s57, s57, 1024
    s_mov_b32 m0, s57
    s_nop 0
    buffer_load_dwordx4 v16, s[28:31], s56 offen nt lds
    s_branch L_kstream
L_noq:
    buffer_load_dwordx4 v[64:67], v2, s[8:11], 0 offen nt
    v_add_u32 v2, s48, v2
    buffer_load_dwordx4 v[68:71], v2, s[8:11], 0 offen nt
    v_add_u32 v2, s48, v2
    buffer_load_dwordx4 v[72:75], v2, s[8:11], 0 offen nt
    v_add_u32 v2, s48, v2
    buffer_load_dwordx4 v[76:79], v2, s[8:11], 0 offen nt
    v_add_u32 v2, s48, v2
    buffer_load_dwordx4 v[80:83], v2, s[8:11], 0 offen nt
    v_add_u32 v2, s48, v2
L_kstream:
    buffer_load_dwordx4 v[84:87], v2, s[8:11], 0 offen nt
    v_add_u32 v2, s48, v2
    buffer_load_dwordx4 v[88:91], v2, s[8:11], 0 offen nt
    v_add_u32 v2, s48, v2
    buffer_load_dwordx4 v[92:95], v2, s[8:11], 0 offen nt
    v_add_u32 v2, s48, v2
    buffer_load_dwordx4 v[96:99], v2, s[8:11], 0 offen nt
    v_add_u32 v2, s48, v2
    buffer_load_dwordx4 v[100:103], v2, s[8:11], 0 offen nt
    v_add_u32 v2, s48, v2
    buffer_load_dwordx4 v[104:107], v2, s[8:11], 0 offen nt
    v_add_u32 v2, s48, v2
    buffer_load_dwordx4 v[108:111], v2, s[8:11], 0 offen nt
    v_add_u32 v2, s48, v2
    buffer_load_dwordx4 v[112:115], v2, s[8:11], 0 offen nt
    v_add_u32 v2, s48, v2
    buffer_load_dwordx4 v[116:119], v2, s[8:11], 0 offen nt
    v_add_u32 v2, s48, v2
    buffer_load_dwordx4 v[120:123], v2, s[8:11], 0 offen nt
    v_add_u32 v2, s48, v2
    buffer_load_dwordx4 v[124:127], v2, s[8:11], 0 offen nt
    v_add_u32 v2, s48, v2
    buffer_load_dwordx4 v[128:131], v2, s[8:11], 0 offen nt
    v_add_u32 v2, s48, v2
    buffer_load_dwordx4 v[132:135], v2, s[8:11], 0 offen nt
    v_add_u32 v2, s48, v2
    buffer_load_dwordx4 v[136:139], v2, s[8:11], 0 offen nt
    v_add_u32 v2, s48, v2
    buffer_load_dwordx4 v[140:143], v2, s[8:11], 0 offen nt
    v_add_u32 v2, s48, v2
    buffer_load_dwordx4 v[144:147], v2, s[8:11], 0 offen nt
    v_add_u32 v2, s48, v2
L_k_mid:
    buffer_load_dwordx4 v[148:151], v2, s[8:11], 0 offen nt
    v_add_u32 v2, s48, v2
    buffer_load_dwordx4 v[152:155], v2, s[8:11], 0 offen nt
    v_add_u32 v2, s48, v2
    buffer_load_dwordx4 v[156:159], v2, s[8:11], 0 offen nt
    v_add_u32 v2, s48, v2
    buffer_load_dwordx4 v[160:163], v2, s[8:11], 0 offen nt
    v_add_u32 v2, s48, v2
    buffer_load_dwordx4 v[164:167], v2, s[8:11], 0 offen nt
    v_add_u32 v2, s48, v2
    buffer_load_dwordx4 v[168:171], v2, s[8:11], 0 offen nt
    v_add_u32 v2, s48, v2
    buffer_load_dwordx4 v[172:175], v2, s[8:11], 0 offen nt
    v_add_u32 v2, s48, v2
    buffer_load_dwordx4 v[176:179], v2, s[8:11], 0 offen nt
    v_add_u32 v2, s48, v2
    buffer_load_dwordx4 v[180:183], v2, s[8:11], 0 offen nt
    v_add_u32 v2, s48, v2
    buffer_load_dwordx4 v[184:187], v2, s[8:11], 0 offen nt
    v_add_u32 v2, s48, v2
    buffer_load_dwordx4 v[188:191], v2, s[8:11], 0 offen nt
    v_add_u32 v2, s48, v2
    buffer_load_dwordx4 v[192:195], v2, s[8:11], 0 offen nt
    v_add_u32 v2, s48, v2
    buffer_load_dwordx4 v[196:199], v2, s[8:11], 0 offen nt
    v_add_u32 v2, s48, v2
    buffer_load_dwordx4 v[200:203], v2, s[8:11], 0 offen nt
    v_add_u32 v2, s48, v2
    buffer_load_dwordx4 v[204:207], v2, s[8:11], 0 offen nt
    v_add_u32 v2, s48, v2
    v_mov_b32 v9, 0
    v_mov_b32 v10, 1
    s_mov_b64 exec, 1
    buffer_load_dword v23, v9, s[40:43], 0 offen
    s_mov_b64 exec, -1
    s_cmp_lg_u32 s3, 0
    s_cbranch_scc1 L_q_skip
    buffer_load_dwordx4 v[40:43], v8, s[16:19], s61 offen sc1
L_q_skip:
    buffer_load_dwordx4 v[208:211], v3, s[12:15], 0 offen nt
    v_subrev_u32 v3, s48, v3
    buffer_load_dwordx4 v[212:215], v3, s[12:15], 0 offen nt
    v_subrev_u32 v3, s48, v3
    buffer_load_dwordx4 v[216:219], v3, s[12:15], 0 offen nt
    v_subrev_u32 v3, s48, v3
    buffer_load_dwordx4 v[220:223], v3, s[12:15], 0 offen nt
    v_subrev_u32 v3, s48, v3
    buffer_load_dwordx4 v[224:227], v3, s[12:15], 0 offen nt
    v_subrev_u32 v3, s48, v3
    buffer_load_dwordx4 v[228:231], v3, s[12:15], 0 offen nt
    v_subrev_u32 v3, s48, v3
    buffer_load_dwordx4 v[232:235], v3, s[12:15], 0 offen nt
    v_subrev_u32 v3, s48, v3
    buffer_load_dwordx4 v[236:239], v3, s[12:15], 0 offen nt
    v_subrev_u32 v3, s48, v3
    buffer_load_dwordx4 v[240:243], v3, s[12:15], 0 offen nt
    v_subrev_u32 v3, s48, v3
    buffer_load_dwordx4 v[244:247], v3, s[12:15], 0 offen nt
    v_subrev_u32 v3, s48, v3
    buffer_load_dwordx4 v[248:251], v3, s[12:15], 0 offen nt
    v_subrev_u32 v3, s48, v3
    buffer_load_dwordx4 v[252:255], v3, s[12:15], 0 offen nt
    v_subrev_u32 v3, s48, v3
    v_cmp_eq_u32 s[56:57], 1, v7
    v_cmp_eq_u32 s[58:59], 2, v7
    v_cmp_eq_u32 s[68:69], 3, v7
    v_and_b32 v16, 1, v1
    v_lshlrev_b32 v16, 4, v16
    v_mov_b32 v17, 0xffff
    v_lshlrev_b32 v17, v16, v17
    v_bfe_u32 v16, v1, 1, 2
    v_cmp_eq_u32 vcc, 0, v16
    s_nop 1
    v_cndmask_b32 v60, 0, v17, vcc
    v_cmp_eq_u32 vcc, 1, v16
    s_nop 1
    v_cndmask_b32 v61, 0, v17, vcc
    v_cmp_eq_u32 vcc, 2, v16
    s_nop 1
    v_cndmask_b32 v62, 0, v17, vcc
    v_cmp_eq_u32 vcc, 3, v16
    s_nop 1
    v_cndmask_b32 v63, 0, v17, vcc
    v_bfe_u32 v11, v1, 2, 3
    v_mul_u32_u24 v11, 44, v11
    v_lshl_add_u32 v11, v7, 1, v11
    v_lshrrev_b32 v12, 5, v1
    v_lshl_add_u32 v29, v7, 1, v12
    v_mov_b32 v0, 0xff800000
    v_add_u32 v11, v11, v12
    v_lshlrev_b32 v11, 2, v11
    s_mul_i32 s63, s3, 1408
    s_add_u32 s63, s63, 4864
    v_add_u32 v11, s63, v11
    v_bfe_u32 v12, v1, 3, 1
    v_lshl_add_u32 v12, v12, 2, v5
    v_mul_u32_u24 v12, 176, v12
    v_add_u32 v12, s63, v12
    s_cmp_lg_u32 s3, 0
    s_cbranch_scc1 L_q_wait
    s_mov_b32 s62, 262144
    s_waitcnt vmcnt(12)
    s_branch L_pchk_3
L_poll_1:
    s_mov_b64 exec, s[64:65]
    buffer_load_dwordx4 v[40:43], v8, s[16:19], s61 offen sc1
    s_mov_b64 exec, -1
    s_waitcnt vmcnt(0)
L_pchk_3:
    v_xor_b32 v30, s4, v41
    v_bitop3_b32 v30, v30, v43, s4 bitop3:0xf6
    v_cmp_ne_u32 s[64:65], 0, v30
    s_cmp_lg_u64 s[64:65], 0
    s_cbranch_scc0 L_pdone_2
    s_sleep 8
    s_sub_u32 s62, s62, 1
    s_cmp_lg_u32 s62, 0
    s_cbranch_scc1 L_poll_1
L_pdone_2:
    v_mov_b32 v41, v42
    v_lshlrev_b32 v16, 3, v1
    ds_write_b64 v16, v[40:41] offset:24320
    s_mov_b64 exec, 1
    ds_add_u32 v9, v10 offset:144
    s_mov_b64 exec, -1
L_q_wait:
    v_bfe_u32 v16, v1, 2, 1
    v_lshlrev_b32 v16, 8, v16
    v_lshl_add_u32 v17, v5, 2, v7
    v_lshl_add_u32 v16, v17, 4, v16
    s_mov_b32 s62, 4194304
L_cw_4:
    ds_read_b32 v31, v9 offset:144
    s_waitcnt lgkmcnt(0)
    v_readfirstlane_b32 s7, v31
    s_cmp_ge_u32 s7, 1
    s_cbranch_scc1 L_cd_5
    s_sleep 2
    s_sub_u32 s62, s62, 1
    s_cmp_lg_u32 s62, 0
    s_cbranch_scc1 L_cw_4
L_cd_5:
    ds_read_b128 v[36:39], v16 offset:24320
    v_cmp_gt_u32 vcc, 8, v6
    s_waitcnt lgkmcnt(0)
    s_nop 0
    v_cndmask_b32 v32, 0, v36, vcc
    v_cndmask_b32 v33, 0, v37, vcc
    v_cndmask_b32 v34, 0, v38, vcc
    v_cndmask_b32 v35, 0, v39, vcc
    v_cndmask_b32 v36, v36, 0, vcc
    v_cndmask_b32 v37, v37, 0, vcc
    v_cndmask_b32 v38, v38, 0, vcc
    v_cndmask_b32 v39, v39, 0, vcc
    s_waitcnt vmcnt(41)
    v_mfma_f32_16x16x32_bf16 v[40:43], v[32:35], v[64:67], 0
    v_mfma_f32_16x16x32_bf16 v[40:43], v[36:39], v[68:71], v[40:43]
    v_mfma_f32_16x16x32_bf16 v[44:47], v[32:35], v[72:75], 0
    v_mfma_f32_16x16x32_bf16 v[44:47], v[36:39], v[76:79], v[44:47]
    v_mfma_f32_16x16x32_bf16 v[48:51], v[32:35], v[80:83], 0
    v_mfma_f32_16x16x32_bf16 v[48:51], v[36:39], v[84:87], v[48:51]
    v_mfma_f32_16x16x32_bf16 v[52:55], v[32:35], v[88:91], 0
    v_mfma_f32_16x16x32_bf16 v[52:55], v[36:39], v[92:95], v[52:55]
    buffer_load_dwordx4 v[64:67], v3, s[12:15], 0 offen nt
    v_subrev_u32 v3, s48, v3
    buffer_load_dwordx4 v[68:71], v3, s[12:15], 0 offen nt
    v_subrev_u32 v3, s48, v3
    buffer_load_dwordx4 v[72:75], v3, s[12:15], 0 offen nt
    v_subrev_u32 v3, s48, v3
    buffer_load_dwordx4 v[76:79], v3, s[12:15], 0 offen nt
    v_subrev_u32 v3, s48, v3
    buffer_load_dwordx4 v[80:83], v3, s[12:15], 0 offen nt
    v_subrev_u32 v3, s48, v3
    buffer_load_dwordx4 v[84:87], v3, s[12:15], 0 offen nt
    v_subrev_u32 v3, s48, v3
    buffer_load_dwordx4 v[88:91], v3, s[12:15], 0 offen nt
    v_subrev_u32 v3, s48, v3
    buffer_load_dwordx4 v[92:95], v3, s[12:15], 0 offen nt
    v_subrev_u32 v3, s48, v3
    v_mov_b32_dpp v16, v40 quad_perm:[0,0,0,0] row_mask:0xf bank_mask:0xf
    v_mov_b32_dpp v17, v44 quad_perm:[0,0,0,0] row_mask:0xf bank_mask:0xf
    v_mov_b32_dpp v18, v48 quad_perm:[0,0,0,0] row_mask:0xf bank_mask:0xf
    v_mov_b32_dpp v19, v52 quad_perm:[0,0,0,0] row_mask:0xf bank_mask:0xf
    v_add_f32_dpp v16, v41, v16 quad_perm:[1,1,1,1] row_mask:0xf bank_mask:0xf
    v_add_f32_dpp v17, v45, v17 quad_perm:[1,1,1,1] row_mask:0xf bank_mask:0xf
    v_add_f32_dpp v18, v49, v18 quad_perm:[1,1,1,1] row_mask:0xf bank_mask:0xf
    v_add_f32_dpp v19, v53, v19 quad_perm:[1,1,1,1] row_mask:0xf bank_mask:0xf
    v_add_f32_dpp v16, v42, v16 quad_perm:[2,2,2,2] row_mask:0xf bank_mask:0xf
    v_add_f32_dpp v17, v46, v17 quad_perm:[2,2,2,2] row_mask:0xf bank_mask:0xf
    v_add_f32_dpp v18, v50, v18 quad_perm:[2,2,2,2] row_mask:0xf bank_mask:0xf
    v_add_f32_dpp v19, v54, v19 quad_perm:[2,2,2,2] row_mask:0xf bank_mask:0xf
    v_add_f32_dpp v16, v43, v16 quad_perm:[3,3,3,3] row_mask:0xf bank_mask:0xf
    v_add_f32_dpp v17, v47, v17 quad_perm:[3,3,3,3] row_mask:0xf bank_mask:0xf
    v_add_f32_dpp v18, v51, v18 quad_perm:[3,3,3,3] row_mask:0xf bank_mask:0xf
    v_add_f32_dpp v19, v55, v19 quad_perm:[3,3,3,3] row_mask:0xf bank_mask:0xf
    v_cndmask_b32 v24, v16, v17, s[56:57]
    v_cndmask_b32 v24, v24, v18, s[58:59]
    v_cndmask_b32 v24, v24, v19, s[68:69]
    s_waitcnt vmcnt(41)
    v_mfma_f32_16x16x32_bf16 v[40:43], v[32:35], v[96:99], 0
    v_mfma_f32_16x16x32_bf16 v[40:43], v[36:39], v[100:103], v[40:43]
    v_mfma_f32_16x16x32_bf16 v[44:47], v[32:35], v[104:107], 0
    v_mfma_f32_16x16x32_bf16 v[44:47], v[36:39], v[108:111], v[44:47]
    v_mfma_f32_16x16x32_bf16 v[48:51], v[32:35], v[112:115], 0
    v_mfma_f32_16x16x32_bf16 v[48:51], v[36:39], v[116:119], v[48:51]
    v_mfma_f32_16x16x32_bf16 v[52:55], v[32:35], v[120:123], 0
    v_mfma_f32_16x16x32_bf16 v[52:55], v[36:39], v[124:127], v[52:55]
    buffer_load_dwordx4 v[96:99], v3, s[12:15], 0 offen nt
    v_subrev_u32 v3, s48, v3
    buffer_load_dwordx4 v[100:103], v3, s[12:15], 0 offen nt
    v_subrev_u32 v3, s48, v3
    buffer_load_dwordx4 v[104:107], v3, s[12:15], 0 offen nt
    v_subrev_u32 v3, s48, v3
    buffer_load_dwordx4 v[108:111], v3, s[12:15], 0 offen nt
    v_subrev_u32 v3, s48, v3
    buffer_load_dwordx4 v[112:115], v3, s[12:15], 0 offen nt
    v_subrev_u32 v3, s48, v3
    buffer_load_dwordx4 v[116:119], v3, s[12:15], 0 offen nt
    v_subrev_u32 v3, s48, v3
    buffer_load_dwordx4 v[120:123], v3, s[12:15], 0 offen nt
    v_subrev_u32 v3, s48, v3
    buffer_load_dwordx4 v[124:127], v3, s[12:15], 0 offen nt
    v_subrev_u32 v3, s48, v3
    v_mov_b32_dpp v16, v40 quad_perm:[0,0,0,0] row_mask:0xf bank_mask:0xf
    v_mov_b32_dpp v17, v44 quad_perm:[0,0,0,0] row_mask:0xf bank_mask:0xf
    v_mov_b32_dpp v18, v48 quad_perm:[0,0,0,0] row_mask:0xf bank_mask:0xf
    v_mov_b32_dpp v19, v52 quad_perm:[0,0,0,0] row_mask:0xf bank_mask:0xf
    v_add_f32_dpp v16, v41, v16 quad_perm:[1,1,1,1] row_mask:0xf bank_mask:0xf
    v_add_f32_dpp v17, v45, v17 quad_perm:[1,1,1,1] row_mask:0xf bank_mask:0xf
    v_add_f32_dpp v18, v49, v18 quad_perm:[1,1,1,1] row_mask:0xf bank_mask:0xf
    v_add_f32_dpp v19, v53, v19 quad_perm:[1,1,1,1] row_mask:0xf bank_mask:0xf
    v_add_f32_dpp v16, v42, v16 quad_perm:[2,2,2,2] row_mask:0xf bank_mask:0xf
    v_add_f32_dpp v17, v46, v17 quad_perm:[2,2,2,2] row_mask:0xf bank_mask:0xf
    v_add_f32_dpp v18, v50, v18 quad_perm:[2,2,2,2] row_mask:0xf bank_mask:0xf
    v_add_f32_dpp v19, v54, v19 quad_perm:[2,2,2,2] row_mask:0xf bank_mask:0xf
    v_add_f32_dpp v16, v43, v16 quad_perm:[3,3,3,3] row_mask:0xf bank_mask:0xf
    v_add_f32_dpp v17, v47, v17 quad_perm:[3,3,3,3] row_mask:0xf bank_mask:0xf
    v_add_f32_dpp v18, v51, v18 quad_perm:[3,3,3,3] row_mask:0xf bank_mask:0xf
    v_add_f32_dpp v19, v55, v19 quad_perm:[3,3,3,3] row_mask:0xf bank_mask:0xf
    v_cndmask_b32 v25, v16, v17, s[56:57]
    v_cndmask_b32 v25, v25, v18, s[58:59]
    v_cndmask_b32 v25, v25, v19, s[68:69]
    s_waitcnt vmcnt(41)
    v_mfma_f32_16x16x32_bf16 v[40:43], v[32:35], v[128:131], 0
    v_mfma_f32_16x16x32_bf16 v[40:43], v[36:39], v[132:135], v[40:43]
    v_mfma_f32_16x16x32_bf16 v[44:47], v[32:35], v[136:139], 0
    v_mfma_f32_16x16x32_bf16 v[44:47], v[36:39], v[140:143], v[44:47]
    v_mfma_f32_16x16x32_bf16 v[48:51], v[32:35], v[144:147], 0
    v_mfma_f32_16x16x32_bf16 v[48:51], v[36:39], v[148:151], v[48:51]
    v_mfma_f32_16x16x32_bf16 v[52:55], v[32:35], v[152:155], 0
    v_mfma_f32_16x16x32_bf16 v[52:55], v[36:39], v[156:159], v[52:55]
    buffer_load_dwordx4 v[128:131], v3, s[12:15], 0 offen nt
    v_subrev_u32 v3, s48, v3
    buffer_load_dwordx4 v[132:135], v3, s[12:15], 0 offen nt
    v_subrev_u32 v3, s48, v3
    buffer_load_dwordx4 v[136:139], v3, s[12:15], 0 offen nt
    v_subrev_u32 v3, s48, v3
    buffer_load_dwordx4 v[140:143], v3, s[12:15], 0 offen nt
    v_subrev_u32 v3, s48, v3
    buffer_load_dwordx4 v[144:147], v3, s[12:15], 0 offen nt
    v_subrev_u32 v3, s48, v3
    buffer_load_dwordx4 v[148:151], v3, s[12:15], 0 offen nt
    v_subrev_u32 v3, s48, v3
    buffer_load_dwordx4 v[152:155], v3, s[12:15], 0 offen nt
    v_subrev_u32 v3, s48, v3
    buffer_load_dwordx4 v[156:159], v3, s[12:15], 0 offen nt
    v_subrev_u32 v3, s48, v3
    v_mov_b32_dpp v16, v40 quad_perm:[0,0,0,0] row_mask:0xf bank_mask:0xf
    v_mov_b32_dpp v17, v44 quad_perm:[0,0,0,0] row_mask:0xf bank_mask:0xf
    v_mov_b32_dpp v18, v48 quad_perm:[0,0,0,0] row_mask:0xf bank_mask:0xf
    v_mov_b32_dpp v19, v52 quad_perm:[0,0,0,0] row_mask:0xf bank_mask:0xf
    v_add_f32_dpp v16, v41, v16 quad_perm:[1,1,1,1] row_mask:0xf bank_mask:0xf
    v_add_f32_dpp v17, v45, v17 quad_perm:[1,1,1,1] row_mask:0xf bank_mask:0xf
    v_add_f32_dpp v18, v49, v18 quad_perm:[1,1,1,1] row_mask:0xf bank_mask:0xf
    v_add_f32_dpp v19, v53, v19 quad_perm:[1,1,1,1] row_mask:0xf bank_mask:0xf
    v_add_f32_dpp v16, v42, v16 quad_perm:[2,2,2,2] row_mask:0xf bank_mask:0xf
    v_add_f32_dpp v17, v46, v17 quad_perm:[2,2,2,2] row_mask:0xf bank_mask:0xf
    v_add_f32_dpp v18, v50, v18 quad_perm:[2,2,2,2] row_mask:0xf bank_mask:0xf
    v_add_f32_dpp v19, v54, v19 quad_perm:[2,2,2,2] row_mask:0xf bank_mask:0xf
    v_add_f32_dpp v16, v43, v16 quad_perm:[3,3,3,3] row_mask:0xf bank_mask:0xf
    v_add_f32_dpp v17, v47, v17 quad_perm:[3,3,3,3] row_mask:0xf bank_mask:0xf
    v_add_f32_dpp v18, v51, v18 quad_perm:[3,3,3,3] row_mask:0xf bank_mask:0xf
    v_add_f32_dpp v19, v55, v19 quad_perm:[3,3,3,3] row_mask:0xf bank_mask:0xf
    v_cndmask_b32 v26, v16, v17, s[56:57]
    v_cndmask_b32 v26, v26, v18, s[58:59]
    v_cndmask_b32 v26, v26, v19, s[68:69]
    s_sub_u32 s7, s50, 16
    v_cmp_gt_i32 vcc, s7, v29
    s_nop 1
    v_cndmask_b32 v26, v0, v26, vcc
    s_waitcnt vmcnt(41)
    v_mfma_f32_16x16x32_bf16 v[40:43], v[32:35], v[160:163], 0
    v_mfma_f32_16x16x32_bf16 v[40:43], v[36:39], v[164:167], v[40:43]
    v_mfma_f32_16x16x32_bf16 v[44:47], v[32:35], v[168:171], 0
    v_mfma_f32_16x16x32_bf16 v[44:47], v[36:39], v[172:175], v[44:47]
    v_mfma_f32_16x16x32_bf16 v[48:51], v[32:35], v[176:179], 0
    v_mfma_f32_16x16x32_bf16 v[48:51], v[36:39], v[180:183], v[48:51]
    v_mfma_f32_16x16x32_bf16 v[52:55], v[32:35], v[184:187], 0
    v_mfma_f32_16x16x32_bf16 v[52:55], v[36:39], v[188:191], v[52:55]
    s_nop 1
    v_mov_b32_dpp v16, v40 quad_perm:[0,0,0,0] row_mask:0xf bank_mask:0xf
    s_nop 0
    v_mov_b32_dpp v17, v44 quad_perm:[0,0,0,0] row_mask:0xf bank_mask:0xf
    s_nop 0
    v_mov_b32_dpp v18, v48 quad_perm:[0,0,0,0] row_mask:0xf bank_mask:0xf
    s_nop 0
    v_mov_b32_dpp v19, v52 quad_perm:[0,0,0,0] row_mask:0xf bank_mask:0xf
    v_add_f32_dpp v16, v41, v16 quad_perm:[1,1,1,1] row_mask:0xf bank_mask:0xf
    v_add_f32_dpp v17, v45, v17 quad_perm:[1,1,1,1] row_mask:0xf bank_mask:0xf
    v_add_f32_dpp v18, v49, v18 quad_perm:[1,1,1,1] row_mask:0xf bank_mask:0xf
    v_add_f32_dpp v19, v53, v19 quad_perm:[1,1,1,1] row_mask:0xf bank_mask:0xf
    v_add_f32_dpp v16, v42, v16 quad_perm:[2,2,2,2] row_mask:0xf bank_mask:0xf
    v_add_f32_dpp v17, v46, v17 quad_perm:[2,2,2,2] row_mask:0xf bank_mask:0xf
    v_add_f32_dpp v18, v50, v18 quad_perm:[2,2,2,2] row_mask:0xf bank_mask:0xf
    v_add_f32_dpp v19, v54, v19 quad_perm:[2,2,2,2] row_mask:0xf bank_mask:0xf
    v_add_f32_dpp v16, v43, v16 quad_perm:[3,3,3,3] row_mask:0xf bank_mask:0xf
    v_add_f32_dpp v17, v47, v17 quad_perm:[3,3,3,3] row_mask:0xf bank_mask:0xf
    v_add_f32_dpp v18, v51, v18 quad_perm:[3,3,3,3] row_mask:0xf bank_mask:0xf
    v_add_f32_dpp v19, v55, v19 quad_perm:[3,3,3,3] row_mask:0xf bank_mask:0xf
    v_cndmask_b32 v27, v16, v17, s[56:57]
    v_cndmask_b32 v27, v27, v18, s[58:59]
    v_cndmask_b32 v27, v27, v19, s[68:69]
    s_sub_u32 s7, s50, 24
    v_cmp_gt_i32 vcc, s7, v29
    s_nop 1
    v_cndmask_b32 v27, v0, v27, vcc
    s_waitcnt vmcnt(37)
    v_mfma_f32_16x16x32_bf16 v[40:43], v[32:35], v[192:195], 0
    v_mfma_f32_16x16x32_bf16 v[40:43], v[36:39], v[196:199], v[40:43]
    v_mfma_f32_16x16x32_bf16 v[44:47], v[32:35], v[200:203], 0
    v_mfma_f32_16x16x32_bf16 v[44:47], v[36:39], v[204:207], v[44:47]
    s_nop 5
    v_mov_b32_dpp v16, v40 quad_perm:[0,0,0,0] row_mask:0xf bank_mask:0xf
    s_nop 0
    v_mov_b32_dpp v17, v44 quad_perm:[0,0,0,0] row_mask:0xf bank_mask:0xf
    v_mov_b32 v18, 0xff800000
    v_mov_b32 v19, 0xff800000
    v_add_f32_dpp v16, v41, v16 quad_perm:[1,1,1,1] row_mask:0xf bank_mask:0xf
    v_add_f32_dpp v17, v45, v17 quad_perm:[1,1,1,1] row_mask:0xf bank_mask:0xf
    s_nop 0
    v_add_f32_dpp v16, v42, v16 quad_perm:[2,2,2,2] row_mask:0xf bank_mask:0xf
    v_add_f32_dpp v17, v46, v17 quad_perm:[2,2,2,2] row_mask:0xf bank_mask:0xf
    s_nop 0
    v_add_f32_dpp v16, v43, v16 quad_perm:[3,3,3,3] row_mask:0xf bank_mask:0xf
    v_add_f32_dpp v17, v47, v17 quad_perm:[3,3,3,3] row_mask:0xf bank_mask:0xf
    v_cndmask_b32 v28, v16, v17, s[56:57]
    v_cndmask_b32 v28, v28, v18, s[58:59]
    v_cndmask_b32 v28, v28, v19, s[68:69]
    s_sub_u32 s7, s50, 32
    v_cmp_gt_i32 vcc, s7, v29
    s_nop 1
    v_cndmask_b32 v28, v0, v28, vcc
    v_cvt_pk_bf16_f32 v16, v24, v25
    v_cvt_pk_bf16_f32 v17, v26, v27
    v_cvt_pk_bf16_f32 v18, v28, v28
    v_lshlrev_b32 v24, 16, v16
    v_and_b32 v25, 0xffff0000, v16
    v_lshlrev_b32 v26, 16, v17
    v_and_b32 v27, 0xffff0000, v17
    v_lshlrev_b32 v28, 16, v18
    v_mul_f32 v24, 0x3db504f3, v24
    v_mul_f32 v25, 0x3db504f3, v25
    v_mul_f32 v26, 0x3db504f3, v26
    v_mul_f32 v27, 0x3db504f3, v27
    v_mul_f32 v28, 0x3db504f3, v28
    v_cvt_pk_bf16_f32 v16, v24, v25
    v_cvt_pk_bf16_f32 v17, v26, v27
    v_cvt_pk_bf16_f32 v18, v28, v28
    v_lshlrev_b32 v24, 16, v16
    v_and_b32 v25, 0xffff0000, v16
    v_lshlrev_b32 v26, 16, v17
    v_and_b32 v27, 0xffff0000, v17
    v_lshlrev_b32 v28, 16, v18
    v_max3_f32 v16, v24, v25, v26
    v_max3_f32 v16, v16, v27, v28
    s_nop 1
    v_max_f32_dpp v16, v16, v16 row_ror:8 row_mask:0xf bank_mask:0xf
    s_nop 1
    v_max_f32_dpp v16, v16, v16 row_ror:4 row_mask:0xf bank_mask:0xf
    s_nop 1
    v_max_f32_dpp v16, v16, v16 row_ror:2 row_mask:0xf bank_mask:0xf
    s_nop 1
    v_max_f32_dpp v16, v16, v16 row_ror:1 row_mask:0xf bank_mask:0xf
    v_mov_b32 v17, v16
    s_nop 1
    v_permlane32_swap_b32 v16, v17
    v_max_f32 v16, v16, v17
    v_sub_f32 v24, v24, v16
    v_sub_f32 v25, v25, v16
    v_sub_f32 v26, v26, v16
    v_sub_f32 v27, v27, v16
    v_sub_f32 v28, v28, v16
    v_mul_f32 v24, 0x3fb8aa3b, v24
    v_mul_f32 v25, 0x3fb8aa3b, v25
    v_mul_f32 v26, 0x3fb8aa3b, v26
    v_mul_f32 v27, 0x3fb8aa3b, v27
    v_mul_f32 v28, 0x3fb8aa3b, v28
    v_exp_f32 v24, v24
    v_exp_f32 v25, v25
    v_exp_f32 v26, v26
    v_exp_f32 v27, v27
    v_exp_f32 v28, v28
    v_cvt_pk_bf16_f32 v44, v24, v24
    v_cvt_pk_bf16_f32 v45, v25, v25
    v_cvt_pk_bf16_f32 v46, v26, v26
    v_cvt_pk_bf16_f32 v47, v27, v27
    v_cvt_pk_bf16_f32 v48, v28, v28
    ds_write_b32 v11, v44 offset:0
    ds_write_b32 v11, v45 offset:32
    ds_write_b32 v11, v46 offset:64
    ds_write_b32 v11, v47 offset:96
    ds_write_b32 v11, v48 offset:128
    v_add_f32 v17, v24, v25
    v_add_f32 v18, v26, v27
    v_add_f32 v17, v17, v18
    v_add_f32 v17, v17, v28
    s_nop 1
    v_add_f32_dpp v17, v17, v17 row_ror:8 row_mask:0xf bank_mask:0xf
    s_nop 1
    v_add_f32_dpp v17, v17, v17 row_ror:4 row_mask:0xf bank_mask:0xf
    s_nop 1
    v_add_f32_dpp v17, v17, v17 row_ror:2 row_mask:0xf bank_mask:0xf
    s_nop 1
    v_add_f32_dpp v17, v17, v17 row_ror:1 row_mask:0xf bank_mask:0xf
    v_mov_b32 v18, v17
    s_nop 1
    v_permlane32_swap_b32 v17, v18
    v_add_f32 v17, v17, v18
    v_bfe_u32 v18, v1, 4, 1
    v_lshlrev_b32 v18, 6, v18
    s_lshl_b32 s7, s3, 3
    v_add_u32 v18, s7, v18
    ds_write_b64 v18, v[16:17] offset:0
    s_mov_b64 exec, 1
    ds_add_u32 v9, v10 offset:132
    s_mov_b64 exec, -1
    s_waitcnt lgkmcnt(0)
    ds_read_b128 v[160:163], v12 offset:0
    ds_read_b128 v[164:167], v12 offset:16
    ds_read_b128 v[168:171], v12 offset:32
    ds_read_b128 v[172:175], v12 offset:48
    ds_read_b128 v[176:179], v12 offset:64
    ds_read_b128 v[180:183], v12 offset:80
    ds_read_b128 v[184:187], v12 offset:96
    ds_read_b128 v[188:191], v12 offset:112
    ds_read_b128 v[192:195], v12 offset:128
    v_lshrrev_b32 v16, 5, v1
    v_lshlrev_b32 v16, 9, v16
    v_lshl_add_u32 v16, v6, 5, v16
    v_bfe_u32 v17, v1, 4, 1
    v_lshl_add_u32 v16, v17, 4, v16
    s_lshl_b32 s7, s3, 10
    s_add_u32 s7, s7, 16128
    v_add_u32 v16, s7, v16
    s_waitcnt lgkmcnt(0)
    v_and_b32 v32, v195, v60
    v_and_b32 v33, v195, v61
    v_and_b32 v34, v195, v62
    v_and_b32 v35, v195, v63
    v_and_b32 v36, v194, v60
    v_and_b32 v37, v194, v61
    v_and_b32 v38, v194, v62
    v_and_b32 v39, v194, v63
    s_waitcnt vmcnt(35)
    v_mfma_f32_16x16x32_bf16 v[40:43], v[32:35], v[208:211], 0
    v_and_b32 v32, v193, v60
    v_and_b32 v33, v193, v61
    v_and_b32 v34, v193, v62
    v_and_b32 v35, v193, v63
    s_waitcnt vmcnt(34)
    v_mfma_f32_16x16x32_bf16 v[40:43], v[36:39], v[212:215], v[40:43]
    v_and_b32 v36, v192, v60
    v_and_b32 v37, v192, v61
    v_and_b32 v38, v192, v62
    v_and_b32 v39, v192, v63
    s_waitcnt vmcnt(33)
    v_mfma_f32_16x16x32_bf16 v[40:43], v[32:35], v[216:219], v[40:43]
    v_and_b32 v32, v191, v60
    v_and_b32 v33, v191, v61
    v_and_b32 v34, v191, v62
    v_and_b32 v35, v191, v63
    s_waitcnt vmcnt(32)
    v_mfma_f32_16x16x32_bf16 v[40:43], v[36:39], v[220:223], v[40:43]
    v_and_b32 v36, v190, v60
    v_and_b32 v37, v190, v61
    v_and_b32 v38, v190, v62
    v_and_b32 v39, v190, v63
    s_waitcnt vmcnt(31)
    v_mfma_f32_16x16x32_bf16 v[40:43], v[32:35], v[224:227], v[40:43]
    v_and_b32 v32, v189, v60
    v_and_b32 v33, v189, v61
    v_and_b32 v34, v189, v62
    v_and_b32 v35, v189, v63
    s_waitcnt vmcnt(30)
    v_mfma_f32_16x16x32_bf16 v[40:43], v[36:39], v[228:231], v[40:43]
    v_and_b32 v36, v188, v60
    v_and_b32 v37, v188, v61
    v_and_b32 v38, v188, v62
    v_and_b32 v39, v188, v63
    s_waitcnt vmcnt(29)
    v_mfma_f32_16x16x32_bf16 v[40:43], v[32:35], v[232:235], v[40:43]
    v_and_b32 v32, v187, v60
    v_and_b32 v33, v187, v61
    v_and_b32 v34, v187, v62
    v_and_b32 v35, v187, v63
    s_waitcnt vmcnt(28)
    v_mfma_f32_16x16x32_bf16 v[40:43], v[36:39], v[236:239], v[40:43]
    v_and_b32 v36, v186, v60
    v_and_b32 v37, v186, v61
    v_and_b32 v38, v186, v62
    v_and_b32 v39, v186, v63
    s_waitcnt vmcnt(27)
    v_mfma_f32_16x16x32_bf16 v[40:43], v[32:35], v[240:243], v[40:43]
    v_and_b32 v32, v185, v60
    v_and_b32 v33, v185, v61
    v_and_b32 v34, v185, v62
    v_and_b32 v35, v185, v63
    s_waitcnt vmcnt(26)
    v_mfma_f32_16x16x32_bf16 v[40:43], v[36:39], v[244:247], v[40:43]
    v_and_b32 v36, v184, v60
    v_and_b32 v37, v184, v61
    v_and_b32 v38, v184, v62
    v_and_b32 v39, v184, v63
    s_waitcnt vmcnt(25)
    v_mfma_f32_16x16x32_bf16 v[40:43], v[32:35], v[248:251], v[40:43]
    v_and_b32 v32, v183, v60
    v_and_b32 v33, v183, v61
    v_and_b32 v34, v183, v62
    v_and_b32 v35, v183, v63
    s_waitcnt vmcnt(24)
    v_mfma_f32_16x16x32_bf16 v[40:43], v[36:39], v[252:255], v[40:43]
    v_and_b32 v36, v182, v60
    v_and_b32 v37, v182, v61
    v_and_b32 v38, v182, v62
    v_and_b32 v39, v182, v63
    s_waitcnt vmcnt(23)
    v_mfma_f32_16x16x32_bf16 v[40:43], v[32:35], v[64:67], v[40:43]
    v_and_b32 v32, v181, v60
    v_and_b32 v33, v181, v61
    v_and_b32 v34, v181, v62
    v_and_b32 v35, v181, v63
    s_waitcnt vmcnt(22)
    v_mfma_f32_16x16x32_bf16 v[40:43], v[36:39], v[68:71], v[40:43]
    v_and_b32 v36, v180, v60
    v_and_b32 v37, v180, v61
    v_and_b32 v38, v180, v62
    v_and_b32 v39, v180, v63
    s_waitcnt vmcnt(21)
    v_mfma_f32_16x16x32_bf16 v[40:43], v[32:35], v[72:75], v[40:43]
    v_and_b32 v32, v179, v60
    v_and_b32 v33, v179, v61
    v_and_b32 v34, v179, v62
    v_and_b32 v35, v179, v63
    s_waitcnt vmcnt(20)
    v_mfma_f32_16x16x32_bf16 v[40:43], v[36:39], v[76:79], v[40:43]
    v_and_b32 v36, v178, v60
    v_and_b32 v37, v178, v61
    v_and_b32 v38, v178, v62
    v_and_b32 v39, v178, v63
    s_waitcnt vmcnt(19)
    v_mfma_f32_16x16x32_bf16 v[40:43], v[32:35], v[80:83], v[40:43]
    v_and_b32 v32, v177, v60
    v_and_b32 v33, v177, v61
    v_and_b32 v34, v177, v62
    v_and_b32 v35, v177, v63
    s_waitcnt vmcnt(18)
    v_mfma_f32_16x16x32_bf16 v[40:43], v[36:39], v[84:87], v[40:43]
    v_and_b32 v36, v176, v60
    v_and_b32 v37, v176, v61
    v_and_b32 v38, v176, v62
    v_and_b32 v39, v176, v63
    s_waitcnt vmcnt(17)
    v_mfma_f32_16x16x32_bf16 v[40:43], v[32:35], v[88:91], v[40:43]
    v_and_b32 v32, v175, v60
    v_and_b32 v33, v175, v61
    v_and_b32 v34, v175, v62
    v_and_b32 v35, v175, v63
    s_waitcnt vmcnt(16)
    v_mfma_f32_16x16x32_bf16 v[40:43], v[36:39], v[92:95], v[40:43]
    v_and_b32 v36, v174, v60
    v_and_b32 v37, v174, v61
    v_and_b32 v38, v174, v62
    v_and_b32 v39, v174, v63
    s_waitcnt vmcnt(15)
    v_mfma_f32_16x16x32_bf16 v[40:43], v[32:35], v[96:99], v[40:43]
    v_and_b32 v32, v173, v60
    v_and_b32 v33, v173, v61
    v_and_b32 v34, v173, v62
    v_and_b32 v35, v173, v63
    s_waitcnt vmcnt(14)
    v_mfma_f32_16x16x32_bf16 v[40:43], v[36:39], v[100:103], v[40:43]
    v_and_b32 v36, v172, v60
    v_and_b32 v37, v172, v61
    v_and_b32 v38, v172, v62
    v_and_b32 v39, v172, v63
    s_waitcnt vmcnt(13)
    v_mfma_f32_16x16x32_bf16 v[40:43], v[32:35], v[104:107], v[40:43]
    v_and_b32 v32, v171, v60
    v_and_b32 v33, v171, v61
    v_and_b32 v34, v171, v62
    v_and_b32 v35, v171, v63
    s_waitcnt vmcnt(12)
    v_mfma_f32_16x16x32_bf16 v[40:43], v[36:39], v[108:111], v[40:43]
    v_and_b32 v36, v170, v60
    v_and_b32 v37, v170, v61
    v_and_b32 v38, v170, v62
    v_and_b32 v39, v170, v63
    s_waitcnt vmcnt(11)
    v_mfma_f32_16x16x32_bf16 v[40:43], v[32:35], v[112:115], v[40:43]
    v_and_b32 v32, v169, v60
    v_and_b32 v33, v169, v61
    v_and_b32 v34, v169, v62
    v_and_b32 v35, v169, v63
    s_waitcnt vmcnt(10)
    v_mfma_f32_16x16x32_bf16 v[40:43], v[36:39], v[116:119], v[40:43]
    v_and_b32 v36, v168, v60
    v_and_b32 v37, v168, v61
    v_and_b32 v38, v168, v62
    v_and_b32 v39, v168, v63
    s_waitcnt vmcnt(9)
    v_mfma_f32_16x16x32_bf16 v[40:43], v[32:35], v[120:123], v[40:43]
    v_and_b32 v32, v167, v60
    v_and_b32 v33, v167, v61
    v_and_b32 v34, v167, v62
    v_and_b32 v35, v167, v63
    s_waitcnt vmcnt(8)
    v_mfma_f32_16x16x32_bf16 v[40:43], v[36:39], v[124:127], v[40:43]
    v_and_b32 v36, v166, v60
    v_and_b32 v37, v166, v61
    v_and_b32 v38, v166, v62
    v_and_b32 v39, v166, v63
    s_waitcnt vmcnt(7)
    v_mfma_f32_16x16x32_bf16 v[40:43], v[32:35], v[128:131], v[40:43]
    v_and_b32 v32, v165, v60
    v_and_b32 v33, v165, v61
    v_and_b32 v34, v165, v62
    v_and_b32 v35, v165, v63
    s_waitcnt vmcnt(6)
    v_mfma_f32_16x16x32_bf16 v[40:43], v[36:39], v[132:135], v[40:43]
    v_and_b32 v36, v164, v60
    v_and_b32 v37, v164, v61
    v_and_b32 v38, v164, v62
    v_and_b32 v39, v164, v63
    s_waitcnt vmcnt(5)
    v_mfma_f32_16x16x32_bf16 v[40:43], v[32:35], v[136:139], v[40:43]
    v_and_b32 v32, v163, v60
    v_and_b32 v33, v163, v61
    v_and_b32 v34, v163, v62
    v_and_b32 v35, v163, v63
    s_waitcnt vmcnt(4)
    v_mfma_f32_16x16x32_bf16 v[40:43], v[36:39], v[140:143], v[40:43]
    v_and_b32 v36, v162, v60
    v_and_b32 v37, v162, v61
    v_and_b32 v38, v162, v62
    v_and_b32 v39, v162, v63
    s_waitcnt vmcnt(3)
    v_mfma_f32_16x16x32_bf16 v[40:43], v[32:35], v[144:147], v[40:43]
    v_and_b32 v32, v161, v60
    v_and_b32 v33, v161, v61
    v_and_b32 v34, v161, v62
    v_and_b32 v35, v161, v63
    s_waitcnt vmcnt(2)
    v_mfma_f32_16x16x32_bf16 v[40:43], v[36:39], v[148:151], v[40:43]
    v_and_b32 v36, v160, v60
    v_and_b32 v37, v160, v61
    v_and_b32 v38, v160, v62
    v_and_b32 v39, v160, v63
    s_waitcnt vmcnt(1)
    v_mfma_f32_16x16x32_bf16 v[40:43], v[32:35], v[152:155], v[40:43]
    s_waitcnt vmcnt(0)
    v_mfma_f32_16x16x32_bf16 v[40:43], v[36:39], v[156:159], v[40:43]
    s_nop 7
    ds_write_b128 v16, v[40:43]
    s_mov_b64 exec, 1
    ds_add_u32 v9, v10 offset:128
    s_mov_b64 exec, -1
    s_cmp_ge_u32 s3, 2
    s_cbranch_scc1 L_pub_done
    v_lshlrev_b32 v15, 3, v1
    s_lshl_b32 s7, s3, 9
    s_add_u32 s7, s7, 16128
    v_add_u32 v15, s7, v15
    v_and_b32 v17, 7, v1
    v_lshlrev_b32 v17, 3, v17
    s_lshl_b32 s7, s3, 6
    v_add_u32 v17, s7, v17
    s_lshl_b32 s56, s44, 1
    s_add_u32 s56, s56, s45
    s_lshl_b32 s56, s56, 3
    s_add_u32 s56, s56, s46
    s_lshl_b32 s56, s56, 11
    s_lshl_b32 s57, s3, 10
    s_add_u32 s56, s56, s57
    s_add_u32 s56, s56, 65536
    s_lshl_b32 s58, s44, 1
    s_add_u32 s58, s58, s3
    s_lshl_b32 s58, s58, 4
    s_lshl_b32 s57, s45, 3
    s_add_u32 s58, s58, s57
    s_add_u32 s58, s58, s46
    s_lshl_b32 s58, s58, 4
    s_add_u32 s58, s58, 36864
    v_lshlrev_b32 v16, 4, v1
    v_mov_b32 v21, s4
    v_mov_b32 v23, s4
    v_mov_b32 v25, s4
    v_mov_b32 v27, s4
    s_mov_b32 s62, 4194304
L_cw_6:
    ds_read_b32 v31, v9 offset:132
    s_waitcnt lgkmcnt(0)
    v_readfirstlane_b32 s7, v31
    s_cmp_ge_u32 s7, 8
    s_cbranch_scc1 L_cd_7
    s_sleep 2
    s_sub_u32 s62, s62, 1
    s_cmp_lg_u32 s62, 0
    s_cbranch_scc1 L_cw_6
L_cd_7:
    ds_read_b64 v[18:19], v17 offset:0
    s_waitcnt lgkmcnt(0)
    v_max_f32_dpp v20, v18, v18 row_ror:4 row_mask:0xf bank_mask:0xf
    s_nop 1
    v_max_f32_dpp v20, v20, v20 row_ror:2 row_mask:0xf bank_mask:0xf
    s_nop 1
    v_max_f32_dpp v20, v20, v20 row_ror:1 row_mask:0xf bank_mask:0xf
    v_sub_f32 v28, v18, v20
    v_mul_f32 v28, 0x3fb8aa3b, v28
    v_exp_f32 v28, v28
    s_nop 0
    v_mul_f32 v22, v19, v28
    s_nop 1
    v_add_f32_dpp v22, v22, v22 row_ror:4 row_mask:0xf bank_mask:0xf
    s_nop 1
    v_add_f32_dpp v22, v22, v22 row_ror:2 row_mask:0xf bank_mask:0xf
    s_nop 1
    v_add_f32_dpp v22, v22, v22 row_ror:1 row_mask:0xf bank_mask:0xf
    s_mov_b64 exec, 1
    buffer_store_dwordx4 v[20:23], v16, s[16:19], s58 offen sc1
    s_mov_b64 exec, -1
    v_mov_b32_dpp v80, v28 row_newbcast:0 row_mask:0xf bank_mask:0xf
    v_mov_b32_dpp v82, v28 row_newbcast:1 row_mask:0xf bank_mask:0xf
    v_mov_b32_dpp v84, v28 row_newbcast:2 row_mask:0xf bank_mask:0xf
    v_mov_b32_dpp v86, v28 row_newbcast:3 row_mask:0xf bank_mask:0xf
    v_mov_b32_dpp v88, v28 row_newbcast:4 row_mask:0xf bank_mask:0xf
    v_mov_b32_dpp v90, v28 row_newbcast:5 row_mask:0xf bank_mask:0xf
    v_mov_b32_dpp v92, v28 row_newbcast:6 row_mask:0xf bank_mask:0xf
    v_mov_b32_dpp v94, v28 row_newbcast:7 row_mask:0xf bank_mask:0xf
    s_setprio 3
    s_mov_b32 s62, 4194304
L_cw_8:
    ds_read_b32 v31, v9 offset:128
    s_waitcnt lgkmcnt(0)
    v_readfirstlane_b32 s7, v31
    s_cmp_ge_u32 s7, 8
    s_cbranch_scc1 L_cd_9
    s_sleep 1
    s_sub_u32 s62, s62, 1
    s_cmp_lg_u32 s62, 0
    s_cbranch_scc1 L_cw_8
L_cd_9:
    ds_read_b64 v[64:65], v15 offset:0
    ds_read_b64 v[66:67], v15 offset:1024
    ds_read_b64 v[68:69], v15 offset:2048
    ds_read_b64 v[70:71], v15 offset:3072
    ds_read_b64 v[72:73], v15 offset:4096
    ds_read_b64 v[74:75], v15 offset:5120
    ds_read_b64 v[76:77], v15 offset:6144
    ds_read_b64 v[78:79], v15 offset:7168
    s_waitcnt lgkmcnt(7)
    v_pk_mul_f32 v[96:97], v[64:65], v[80:81] op_sel_hi:[1,0]
    s_waitcnt lgkmcnt(6)
    v_pk_mul_f32 v[98:99], v[66:67], v[82:83] op_sel_hi:[1,0]
    s_waitcnt lgkmcnt(5)
    v_pk_fma_f32 v[96:97], v[68:69], v[84:85], v[96:97] op_sel_hi:[1,0,1]
    s_waitcnt lgkmcnt(4)
    v_pk_fma_f32 v[98:99], v[70:71], v[86:87], v[98:99] op_sel_hi:[1,0,1]
    s_waitcnt lgkmcnt(3)
    v_pk_fma_f32 v[96:97], v[72:73], v[88:89], v[96:97] op_sel_hi:[1,0,1]
    s_waitcnt lgkmcnt(2)
    v_pk_fma_f32 v[98:99], v[74:75], v[90:91], v[98:99] op_sel_hi:[1,0,1]
    s_waitcnt lgkmcnt(1)
    v_pk_fma_f32 v[96:97], v[76:77], v[92:93], v[96:97] op_sel_hi:[1,0,1]
    s_waitcnt lgkmcnt(0)
    v_pk_fma_f32 v[98:99], v[78:79], v[94:95], v[98:99] op_sel_hi:[1,0,1]
    v_add_f32 v24, v96, v98
    v_add_f32 v26, v97, v99
    buffer_store_dwordx4 v[24:27], v16, s[16:19], s56 offen sc1
    s_setprio 0
    s_mov_b64 exec, 1
    ds_add_u32 v9, v10 offset:140
    s_mov_b64 exec, -1
L_pub_done:
    s_cmp_lg_u32 s3, 3
    s_cbranch_scc1 L_nopf
    s_getpc_b64 s[56:57]
    s_lshr_b32 s7, s2, 3
    s_lshl_b32 s7, s7, 8
    v_lshlrev_b32 v16, 7, v1
    v_add_u32 v16, s7, v16
    s_mov_b64 exec, 3
    global_load_dword v17, v16, s[56:57]
    s_mov_b64 exec, -1
    s_waitcnt vmcnt(0)
L_nopf:
    s_cmp_eq_u32 s5, 0
    s_cbranch_scc1 L_ffn
    s_cmp_eq_u32 s5, 1
    s_cbranch_scc1 L_wo
    s_and_b32 s7, s47, 15
    s_cmp_ge_u32 s7, 9
    s_cbranch_scc1 L_fin
    s_lshr_b32 s47, s47, 4
    s_mul_i32 s47, s47, 9
    s_add_u32 s47, s47, s7
    v_lshrrev_b32 v26, 3, v1
    v_mul_u32_u24 v26, 4608, v26
    v_and_b32 v17, 7, v1
    v_lshl_add_u32 v26, v17, 4, v26
    s_lshl_b32 s53, s47, 7
    s_mul_i32 s7, s3, 36864
    s_add_u32 s53, s53, s7
    s_add_u32 s53, s53, 589824
    v_lshrrev_b32 v19, 5, v1
    v_mul_u32_u24 v29, 1152, v19
    v_lshl_add_u32 v29, v17, 2, v29
    s_lshl_b32 s7, s47, 5
    buffer_load_dword v14, v29, s[20:23], s7 offen
    v_bfe_u32 v29, v1, 3, 2
    v_lshlrev_b32 v29, 13, v29
    v_lshl_add_u32 v29, v17, 4, v29
    v_lshl_add_u32 v29, v19, 3, v29
    s_lshl_b32 s52, s47, 7
    s_add_u32 s52, s52, 983040
    s_add_u32 s51, s52, 32768
    v_lshlrev_b32 v27, 4, v1
    v_mov_b32 v21, s4
    s_lshr_b32 s7, s3, 1
    s_lshl_b32 s7, s7, 10
    s_and_b32 s63, s3, 1
    s_lshl_b32 s63, s63, 3
    s_add_u32 s7, s7, s63
    s_add_u32 s7, s7, 16128
    v_add_u32 v13, s7, v27
    v_bfe_u32 v100, v1, 3, 1
    v_lshlrev_b32 v100, 4, v100
    v_mov_b32 v101, 0x3f80
    v_lshlrev_b32 v101, v100, v101
    v_and_b32 v100, 1, v1
    v_cmp_eq_u32 vcc, 1, v100
    s_nop 1
    v_cndmask_b32 v100, v101, 0, vcc
    v_cndmask_b32 v101, 0, v101, vcc
    v_mov_b32 v102, v100
    v_mov_b32 v103, v101
    s_mov_b32 s62, 4194304
L_cw_10:
    ds_read_b32 v31, v9 offset:140
    s_waitcnt lgkmcnt(0)
    v_readfirstlane_b32 s7, v31
    s_cmp_ge_u32 s7, 2
    s_cbranch_scc1 L_cd_11
    s_sleep 1
    s_sub_u32 s62, s62, 1
    s_cmp_lg_u32 s62, 0
    s_cbranch_scc1 L_cw_10
L_cd_11:
    s_mov_b32 s62, 262144
    s_mov_b64 s[64:65], -1
    s_mov_b64 exec, -1
L_poll_12:
    s_mov_b64 exec, s[64:65]
    buffer_load_dwordx4 v[192:195], v26, s[16:19], s53 offen sc1
    s_mov_b64 exec, -1
    s_waitcnt vmcnt(0)
L_pchk_14:
    v_xor_b32 v30, s4, v193
    v_bitop3_b32 v30, v30, v195, s4 bitop3:0xf6
    v_cmp_ne_u32 s[64:65], 0, v30
    s_cmp_lg_u64 s[64:65], 0
    s_cbranch_scc0 L_pdone_13
    s_sub_u32 s62, s62, 1
    s_cmp_lg_u32 s62, 0
    s_cbranch_scc1 L_poll_12
L_pdone_13:
    ds_write2_b32 v13, v192, v194 offset0:0 offset1:1
    s_waitcnt lgkmcnt(0)
    s_barrier
    s_cmp_lg_u32 s3, 0
    s_cbranch_scc1 L_fin
    ds_read_b128 v[68:71], v27 offset:16128
    ds_read_b128 v[72:75], v27 offset:17152
    ds_read_b128 v[76:79], v27 offset:18176
    ds_read_b128 v[80:83], v27 offset:19200
    v_lshlrev_b32 v98, 16, v14
    v_and_b32 v99, 0xffff0000, v14
    s_waitcnt lgkmcnt(3)
    v_mfma_f32_16x16x32_bf16 v[64:67], v[100:103], v[68:71], 0
    s_waitcnt lgkmcnt(2)
    v_mfma_f32_16x16x32_bf16 v[64:67], v[100:103], v[72:75], v[64:67]
    s_waitcnt lgkmcnt(1)
    v_mfma_f32_16x16x32_bf16 v[64:67], v[100:103], v[76:79], v[64:67]
    s_waitcnt lgkmcnt(0)
    v_mfma_f32_16x16x32_bf16 v[64:67], v[100:103], v[80:83], v[64:67]
    s_nop 7
    v_add_f32_dpp v64, v64, v64 row_ror:8 row_mask:0xf bank_mask:0xf
    v_add_f32_dpp v65, v65, v65 row_ror:8 row_mask:0xf bank_mask:0xf
    v_cvt_pk_bf16_f32 v64, v64, v65
    v_lshlrev_b32 v96, 16, v64
    v_and_b32 v97, 0xffff0000, v64
    v_add_f32 v96, v96, v98
    v_add_f32 v97, v97, v99
    v_cvt_pk_bf16_f32 v20, v96, v97
    buffer_store_dwordx2 v[20:21], v29, s[16:19], s52 offen sc1
    buffer_store_dwordx2 v[20:21], v29, s[16:19], s51 offen sc1
    s_branch L_fin
L_wo:
    v_lshrrev_b32 v19, 5, v1
    v_cmp_eq_u32 s[56:57], 1, v5
    v_cmp_eq_u32 s[58:59], 2, v5
    v_cmp_eq_u32 s[60:61], 3, v5
    v_and_b32 v28, 1, v1
    v_mul_u32_u24 v28, 144, v28
    v_lshl_add_u32 v28, v5, 4, v28
    s_mul_i32 s7, s6, 4608
    s_add_u32 s7, s7, 589824
    s_lshl_b32 s54, s3, 9
    s_add_u32 s54, s54, s7
    s_lshl_b32 s55, s3, 7
    s_add_u32 s55, s55, s7
    s_add_u32 s55, s55, 4096
    v_lshlrev_b32 v27, 4, v1
    v_lshlrev_b32 v11, 3, v1
    v_mov_b32 v21, s4
    v_mov_b32 v23, s4
    v_mov_b32 v61, s4
    v_lshrrev_b32 v24, 2, v1
    v_lshlrev_b32 v25, 4, v24
    v_lshlrev_b32 v24, 11, v24
    v_and_b32 v17, 3, v1
    v_lshl_add_u32 v24, v17, 4, v24
    s_lshr_b32 s7, s6, 2
    s_lshl_b32 s48, s7, 15
    s_and_b32 s7, s6, 3
    s_lshl_b32 s7, s7, 9
    s_add_u32 s48, s48, s7
    s_lshl_b32 s7, s3, 6
    s_add_u32 s48, s48, s7
    s_add_u32 s48, s48, 65536
    s_lshr_b32 s49, s6, 1
    s_lshl_b32 s49, s49, 8
    s_add_u32 s49, s49, 36864
    v_mul_u32_u24 v15, 144, v19
    v_lshl_add_u32 v15, v17, 2, v15
    v_bfe_u32 v17, v1, 4, 1
    v_lshl_add_u32 v15, v17, 1, v15
    s_lshl_b32 s7, s3, 4
    v_add_u32 v15, s7, v15
    s_mov_b32 s62, 4194304
L_cw_15:
    ds_read_b32 v31, v9 offset:128
    s_waitcnt lgkmcnt(0)
    v_readfirstlane_b32 s7, v31
    s_cmp_ge_u32 s7, 8
    s_cbranch_scc1 L_cd_16
    s_sleep 1
    s_sub_u32 s62, s62, 1
    s_cmp_lg_u32 s62, 0
    s_cbranch_scc1 L_cw_15
L_cd_16:
    buffer_load_dwordx4 v[136:139], v24, s[16:19], s48 offen sc1
    buffer_load_dwordx4 v[128:131], v25, s[16:19], s49 offen sc1
    v_lshrrev_b32 v17, 2, v6
    v_lshl_add_u32 v16, v5, 3, v17
    v_mul_u32_u24 v16, 1152, v16
    v_and_b32 v17, 3, v1
    v_lshl_add_u32 v16, v17, 3, v16
    s_lshl_b32 s7, s3, 7
    s_add_u32 s7, s7, 25088
    v_add_u32 v17, s7, v16
    s_and_b32 s7, s3, 3
    s_lshl_b32 s7, s7, 5
    s_add_u32 s7, s7, 26112
    v_add_u32 v16, s7, v16
    ds_read_b64_tr_b16 v[64:65], v17 offset:0
    ds_read_b64_tr_b16 v[66:67], v17 offset:4608
    ds_read_b64_tr_b16 v[68:69], v17 offset:36864
    ds_read_b64_tr_b16 v[70:71], v17 offset:41472
    ds_read_b64_tr_b16 v[72:73], v17 offset:32
    ds_read_b64_tr_b16 v[74:75], v17 offset:4640
    ds_read_b64_tr_b16 v[76:77], v17 offset:36896
    ds_read_b64_tr_b16 v[78:79], v17 offset:41504
    ds_read_b64_tr_b16 v[80:81], v17 offset:64
    ds_read_b64_tr_b16 v[82:83], v17 offset:4672
    ds_read_b64_tr_b16 v[84:85], v17 offset:36928
    ds_read_b64_tr_b16 v[86:87], v17 offset:41536
    ds_read_b64_tr_b16 v[88:89], v17 offset:96
    ds_read_b64_tr_b16 v[90:91], v17 offset:4704
    ds_read_b64_tr_b16 v[92:93], v17 offset:36960
    ds_read_b64_tr_b16 v[94:95], v17 offset:41568
    ds_read_b64_tr_b16 v[96:97], v16 offset:0
    ds_read_b64_tr_b16 v[98:99], v16 offset:4608
    ds_read_b64_tr_b16 v[100:101], v16 offset:36864
    ds_read_b64_tr_b16 v[102:103], v16 offset:41472
    s_mov_b32 s62, 262144
    s_waitcnt vmcnt(0)
    s_branch L_pchk_19
L_poll_17:
    s_mov_b64 exec, s[64:65]
    buffer_load_dwordx4 v[128:131], v25, s[16:19], s49 offen sc1
    s_mov_b64 exec, -1
    s_waitcnt vmcnt(0)
L_pchk_19:
    v_xor_b32 v30, s4, v129
    v_bitop3_b32 v30, v30, v131, s4 bitop3:0xf6
    v_cmp_ne_u32 s[64:65], 0, v30
    s_cmp_lg_u64 s[64:65], 0
    s_cbranch_scc0 L_pdone_18
    s_sleep 1
    s_sub_u32 s62, s62, 1
    s_cmp_lg_u32 s62, 0
    s_cbranch_scc1 L_poll_17
L_pdone_18:
    v_max_f32_dpp v132, v128, v128 row_ror:4 row_mask:0xf bank_mask:0xf
    s_nop 1
    v_max_f32_dpp v132, v132, v132 row_ror:8 row_mask:0xf bank_mask:0xf
    v_mov_b32 v133, v132
    s_nop 1
    v_permlane16_swap_b32 v132, v133
    v_max_f32 v132, v132, v133
    v_sub_f32 v132, v128, v132
    v_mul_f32 v132, 0x3fb8aa3b, v132
    v_exp_f32 v132, v132
    s_nop 0
    v_mul_f32 v133, v130, v132
    s_nop 1
    v_add_f32_dpp v133, v133, v133 row_ror:4 row_mask:0xf bank_mask:0xf
    s_nop 1
    v_add_f32_dpp v133, v133, v133 row_ror:8 row_mask:0xf bank_mask:0xf
    v_mov_b32 v134, v133
    s_nop 1
    v_permlane16_swap_b32 v133, v134
    v_add_f32 v133, v133, v134
    v_rcp_f32 v133, v133
    s_nop 0
    v_mul_f32 v132, v132, v133
    s_mov_b32 s62, 262144
    s_waitcnt vmcnt(0)
    s_branch L_pchk_22
L_poll_20:
    s_mov_b64 exec, s[64:65]
    buffer_load_dwordx4 v[136:139], v24, s[16:19], s48 offen sc1
    s_mov_b64 exec, -1
    s_waitcnt vmcnt(0)
L_pchk_22:
    v_xor_b32 v30, s4, v137
    v_bitop3_b32 v30, v30, v139, s4 bitop3:0xf6
    v_cmp_ne_u32 s[64:65], 0, v30
    s_cmp_lg_u64 s[64:65], 0
    s_cbranch_scc0 L_pdone_21
    s_sub_u32 s62, s62, 1
    s_cmp_lg_u32 s62, 0
    s_cbranch_scc1 L_poll_20
L_pdone_21:
    v_mul_f32 v140, v136, v132
    v_mul_f32 v141, v138, v132
    s_nop 1
    v_permlane16_swap_b32 v140, v141
    v_add_f32 v140, v140, v141
    s_nop 1
    v_add_f32_dpp v140, v140, v140 row_ror:4 row_mask:0xf bank_mask:0xf
    s_nop 1
    v_add_f32_dpp v140, v140, v140 row_ror:8 row_mask:0xf bank_mask:0xf
    v_cvt_pk_bf16_f32 v140, v140, v140
    ds_write_b16 v15, v140 offset:256
    s_waitcnt lgkmcnt(0)
    s_barrier
    ds_read_b128 v[32:35], v28 offset:256
    ds_read_b128 v[36:39], v28 offset:320
    s_cmp_ge_u32 s3, 4
    s_waitcnt lgkmcnt(0)
    v_mfma_f32_16x16x32_bf16 v[40:43], v[32:35], v[64:67], 0
    v_mfma_f32_16x16x32_bf16 v[40:43], v[36:39], v[68:71], v[40:43]
    v_mfma_f32_16x16x32_bf16 v[44:47], v[32:35], v[72:75], 0
    v_mfma_f32_16x16x32_bf16 v[44:47], v[36:39], v[76:79], v[44:47]
    v_mfma_f32_16x16x32_bf16 v[48:51], v[32:35], v[80:83], 0
    v_mfma_f32_16x16x32_bf16 v[48:51], v[36:39], v[84:87], v[48:51]
    v_mfma_f32_16x16x32_bf16 v[52:55], v[32:35], v[88:91], 0
    v_mfma_f32_16x16x32_bf16 v[52:55], v[36:39], v[92:95], v[52:55]
    s_cbranch_scc1 L_nox_23a
    v_mfma_f32_16x16x32_bf16 v[56:59], v[32:35], v[96:99], 0
    v_mfma_f32_16x16x32_bf16 v[56:59], v[36:39], v[100:103], v[56:59]
L_nox_23a:
    s_nop 3
    v_cvt_pk_bf16_f32 v40, v40, v41
    v_cvt_pk_bf16_f32 v44, v44, v45
    v_cvt_pk_bf16_f32 v48, v48, v49
    v_cvt_pk_bf16_f32 v52, v52, v53
    v_cndmask_b32 v20, v40, v44, s[56:57]
    v_cndmask_b32 v20, v20, v48, s[58:59]
    v_cndmask_b32 v20, v20, v52, s[60:61]
    buffer_store_dwordx2 v[20:21], v11, s[16:19], s54 offen sc1
    s_cbranch_scc1 L_nox_23
    v_cvt_pk_bf16_f32 v60, v56, v57
    s_mov_b64 exec, 0xffff
    buffer_store_dwordx2 v[60:61], v11, s[16:19], s55 offen sc1
    s_mov_b64 exec, -1
L_nox_23:
    s_branch L_fin
L_ffn:
    s_mul_i32 s7, s6, 4608
    s_add_u32 s7, s7, 65536
    s_lshl_b32 s54, s3, 9
    s_add_u32 s54, s54, s7
    s_lshl_b32 s55, s3, 7
    s_add_u32 s55, s55, s7
    s_add_u32 s55, s55, 4096
    v_lshlrev_b32 v27, 4, v1
    v_lshlrev_b32 v11, 3, v1
    v_mov_b32 v21, s4
    v_mov_b32 v23, s4
    v_mov_b32 v61, s4
    s_and_b32 s44, s2, 7
    s_lshl_b32 s44, s44, 13
    s_add_u32 s44, s44, 983040
    s_cmp_lg_u32 s3, 2
    s_cbranch_scc1 L_ffn_dd
    v_lshrrev_b32 v16, 2, v1
    v_mul_u32_u24 v16, 9216, v16
    v_and_b32 v17, 3, v1
    v_lshrrev_b32 v18, 5, v1
    v_xor_b32 v17, v17, v18
    v_lshl_add_u32 v16, v17, 4, v16
    s_lshl_b32 s56, s6, 6
    s_mov_b32 s57, 61984
    s_mul_i32 s58, s6, 36864
    s_mov_b32 s59, 99072
    s_mov_b32 s62, 4194304
L_cw_24:
    ds_read_b32 v31, v9 offset:140
    s_waitcnt lgkmcnt(0)
    v_readfirstlane_b32 s7, v31
    s_cmp_ge_u32 s7, 2
    s_cbranch_scc1 L_cd_25
    s_sleep 1
    s_sub_u32 s62, s62, 1
    s_cmp_lg_u32 s62, 0
    s_cbranch_scc1 L_cw_24
L_cd_25:
    s_mov_b32 m0, s57
    s_nop 0
    buffer_load_dwordx4 v16, s[32:35], s56 offen nt lds
    s_add_u32 s56, s56, 147456
    s_add_u32 s57, s57, 1024
    s_mov_b32 m0, s57
    s_nop 0
    buffer_load_dwordx4 v16, s[32:35], s56 offen nt lds
    s_add_u32 s56, s56, 147456
    s_add_u32 s57, s57, 1024
    s_mov_b32 m0, s57
    s_nop 0
    buffer_load_dwordx4 v16, s[32:35], s56 offen nt lds
    s_add_u32 s56, s56, 147456
    s_add_u32 s57, s57, 1024
    s_mov_b32 m0, s57
    s_nop 0
    buffer_load_dwordx4 v16, s[32:35], s56 offen nt lds
    s_add_u32 s56, s56, 147456
    s_add_u32 s57, s57, 1024
    s_mov_b32 m0, s57
    s_nop 0
    buffer_load_dwordx4 v16, s[32:35], s56 offen nt lds
    s_add_u32 s56, s56, 147456
    s_add_u32 s57, s57, 1024
    s_mov_b32 m0, s57
    s_nop 0
    buffer_load_dwordx4 v16, s[32:35], s56 offen nt lds
    s_add_u32 s56, s56, 147456
    s_add_u32 s57, s57, 1024
    s_mov_b32 m0, s57
    s_nop 0
    buffer_load_dwordx4 v16, s[32:35], s56 offen nt lds
    s_add_u32 s56, s56, 147456
    s_add_u32 s57, s57, 1024
    s_mov_b32 m0, s57
    s_nop 0
    buffer_load_dwordx4 v16, s[32:35], s56 offen nt lds
    s_add_u32 s56, s56, 147456
    s_add_u32 s57, s57, 1024
    s_mov_b32 m0, s57
    s_nop 0
    buffer_load_dwordx4 v16, s[32:35], s56 offen nt lds
    s_add_u32 s56, s56, 147456
    s_add_u32 s57, s57, 1024
    s_mov_b32 m0, s57
    s_nop 0
    buffer_load_dwordx4 v16, s[32:35], s56 offen nt lds
    s_add_u32 s56, s56, 147456
    s_add_u32 s57, s57, 1024
    s_mov_b32 m0, s57
    s_nop 0
    buffer_load_dwordx4 v16, s[32:35], s56 offen nt lds
    s_add_u32 s56, s56, 147456
    s_add_u32 s57, s57, 1024
    s_mov_b32 m0, s57
    s_nop 0
    buffer_load_dwordx4 v16, s[32:35], s56 offen nt lds
    s_add_u32 s56, s56, 147456
    s_add_u32 s57, s57, 1024
    s_mov_b32 m0, s57
    s_nop 0
    buffer_load_dwordx4 v16, s[32:35], s56 offen nt lds
    s_add_u32 s56, s56, 147456
    s_add_u32 s57, s57, 1024
    s_mov_b32 m0, s57
    s_nop 0
    buffer_load_dwordx4 v16, s[32:35], s56 offen nt lds
    s_add_u32 s56, s56, 147456
    s_add_u32 s57, s57, 1024
    s_mov_b32 m0, s57
    s_nop 0
    buffer_load_dwordx4 v16, s[32:35], s56 offen nt lds
    s_add_u32 s56, s56, 147456
    s_add_u32 s57, s57, 1024
    s_mov_b32 m0, s57
    s_nop 0
    buffer_load_dwordx4 v16, s[32:35], s56 offen nt lds
    s_add_u32 s56, s56, 147456
    s_add_u32 s57, s57, 1024
    s_mov_b32 m0, s57
    s_nop 0
    buffer_load_dwordx4 v16, s[32:35], s56 offen nt lds
    s_add_u32 s56, s56, 147456
    s_add_u32 s57, s57, 1024
    s_mov_b32 m0, s57
    s_nop 0
    buffer_load_dwordx4 v16, s[32:35], s56 offen nt lds
    s_add_u32 s56, s56, 147456
    s_add_u32 s57, s57, 1024
    s_mov_b32 m0, s57
    s_nop 0
    buffer_load_dwordx4 v16, s[32:35], s56 offen nt lds
    s_add_u32 s56, s56, 147456
    s_add_u32 s57, s57, 1024
    s_mov_b32 m0, s57
    s_nop 0
    buffer_load_dwordx4 v16, s[32:35], s56 offen nt lds
    s_add_u32 s56, s56, 147456
    s_add_u32 s57, s57, 1024
    s_mov_b32 m0, s57
    s_nop 0
    buffer_load_dwordx4 v16, s[32:35], s56 offen nt lds
    s_add_u32 s56, s56, 147456
    s_add_u32 s57, s57, 1024
    s_mov_b32 m0, s57
    s_nop 0
    buffer_load_dwordx4 v16, s[32:35], s56 offen nt lds
    s_add_u32 s56, s56, 147456
    s_add_u32 s57, s57, 1024
    s_mov_b32 m0, s57
    s_nop 0
    buffer_load_dwordx4 v16, s[32:35], s56 offen nt lds
    s_add_u32 s56, s56, 147456
    s_add_u32 s57, s57, 1024
    s_mov_b32 m0, s57
    s_nop 0
    buffer_load_dwordx4 v16, s[32:35], s56 offen nt lds
    s_add_u32 s56, s56, 147456
    s_add_u32 s57, s57, 1024
    s_mov_b32 m0, s57
    s_nop 0
    buffer_load_dwordx4 v16, s[32:35], s56 offen nt lds
    s_add_u32 s56, s56, 147456
    s_add_u32 s57, s57, 1024
    s_mov_b32 m0, s57
    s_nop 0
    buffer_load_dwordx4 v16, s[32:35], s56 offen nt lds
    s_add_u32 s56, s56, 147456
    s_add_u32 s57, s57, 1024
    s_mov_b32 m0, s57
    s_nop 0
    buffer_load_dwordx4 v16, s[32:35], s56 offen nt lds
    s_add_u32 s56, s56, 147456
    s_add_u32 s57, s57, 1024
    s_mov_b32 m0, s57
    s_nop 0
    buffer_load_dwordx4 v16, s[32:35], s56 offen nt lds
    s_add_u32 s56, s56, 147456
    s_add_u32 s57, s57, 1024
    s_mov_b32 m0, s57
    s_nop 0
    buffer_load_dwordx4 v16, s[32:35], s56 offen nt lds
    s_add_u32 s56, s56, 147456
    s_add_u32 s57, s57, 1024
    s_mov_b32 m0, s57
    s_nop 0
    buffer_load_dwordx4 v16, s[32:35], s56 offen nt lds
    s_add_u32 s56, s56, 147456
    s_add_u32 s57, s57, 1024
    s_mov_b32 m0, s57
    s_nop 0
    buffer_load_dwordx4 v16, s[32:35], s56 offen nt lds
    s_add_u32 s56, s56, 147456
    s_add_u32 s57, s57, 1024
    s_mov_b32 m0, s57
    s_nop 0
    buffer_load_dwordx4 v16, s[32:35], s56 offen nt lds
    s_add_u32 s56, s56, 147456
    s_add_u32 s57, s57, 1024
    s_mov_b32 m0, s57
    s_nop 0
    buffer_load_dwordx4 v16, s[32:35], s56 offen nt lds
    s_add_u32 s56, s56, 147456
    s_add_u32 s57, s57, 1024
    s_mov_b32 m0, s57
    s_nop 0
    buffer_load_dwordx4 v16, s[32:35], s56 offen nt lds
    s_add_u32 s56, s56, 147456
    s_add_u32 s57, s57, 1024
    s_mov_b32 m0, s57
    s_nop 0
    buffer_load_dwordx4 v16, s[32:35], s56 offen nt lds
    s_add_u32 s56, s56, 147456
    s_add_u32 s57, s57, 1024
    s_mov_b32 m0, s57
    s_nop 0
    buffer_load_dwordx4 v16, s[32:35], s56 offen nt lds
    s_mov_b32 m0, s59
    s_nop 0
    buffer_load_dwordx4 v27, s[36:39], s58 offen nt lds
    s_add_u32 s58, s58, 1024
    s_add_u32 s59, s59, 1024
    s_mov_b32 m0, s59
    s_nop 0
    buffer_load_dwordx4 v27, s[36:39], s58 offen nt lds
    s_add_u32 s58, s58, 1024
    s_add_u32 s59, s59, 1024
    s_mov_b32 m0, s59
    s_nop 0
    buffer_load_dwordx4 v27, s[36:39], s58 offen nt lds
    s_add_u32 s58, s58, 1024
    s_add_u32 s59, s59, 1024
    s_mov_b32 m0, s59
    s_nop 0
    buffer_load_dwordx4 v27, s[36:39], s58 offen nt lds
    s_add_u32 s58, s58, 1024
    s_add_u32 s59, s59, 1024
    s_mov_b32 m0, s59
    s_nop 0
    buffer_load_dwordx4 v27, s[36:39], s58 offen nt lds
    s_add_u32 s58, s58, 1024
    s_add_u32 s59, s59, 1024
    s_mov_b32 m0, s59
    s_nop 0
    buffer_load_dwordx4 v27, s[36:39], s58 offen nt lds
    s_add_u32 s58, s58, 1024
    s_add_u32 s59, s59, 1024
    s_mov_b32 m0, s59
    s_nop 0
    buffer_load_dwordx4 v27, s[36:39], s58 offen nt lds
    s_add_u32 s58, s58, 1024
    s_add_u32 s59, s59, 1024
    s_mov_b32 m0, s59
    s_nop 0
    buffer_load_dwordx4 v27, s[36:39], s58 offen nt lds
    s_add_u32 s58, s58, 1024
    s_add_u32 s59, s59, 1024
    s_mov_b32 m0, s59
    s_nop 0
    buffer_load_dwordx4 v27, s[36:39], s58 offen nt lds
    s_add_u32 s58, s58, 1024
    s_add_u32 s59, s59, 1024
    s_mov_b32 m0, s59
    s_nop 0
    buffer_load_dwordx4 v27, s[36:39], s58 offen nt lds
    s_add_u32 s58, s58, 1024
    s_add_u32 s59, s59, 1024
    s_mov_b32 m0, s59
    s_nop 0
    buffer_load_dwordx4 v27, s[36:39], s58 offen nt lds
    s_add_u32 s58, s58, 1024
    s_add_u32 s59, s59, 1024
    s_mov_b32 m0, s59
    s_nop 0
    buffer_load_dwordx4 v27, s[36:39], s58 offen nt lds
    s_add_u32 s58, s58, 1024
    s_add_u32 s59, s59, 1024
    s_mov_b32 m0, s59
    s_nop 0
    buffer_load_dwordx4 v27, s[36:39], s58 offen nt lds
    s_add_u32 s58, s58, 1024
    s_add_u32 s59, s59, 1024
    s_mov_b32 m0, s59
    s_nop 0
    buffer_load_dwordx4 v27, s[36:39], s58 offen nt lds
    s_add_u32 s58, s58, 1024
    s_add_u32 s59, s59, 1024
    s_mov_b32 m0, s59
    s_nop 0
    buffer_load_dwordx4 v27, s[36:39], s58 offen nt lds
    s_add_u32 s58, s58, 1024
    s_add_u32 s59, s59, 1024
    s_mov_b32 m0, s59
    s_nop 0
    buffer_load_dwordx4 v27, s[36:39], s58 offen nt lds
    s_add_u32 s58, s58, 1024
    s_add_u32 s59, s59, 1024
    s_mov_b32 m0, s59
    s_nop 0
    buffer_load_dwordx4 v27, s[36:39], s58 offen nt lds
    s_add_u32 s58, s58, 1024
    s_add_u32 s59, s59, 1024
    s_mov_b32 m0, s59
    s_nop 0
    buffer_load_dwordx4 v27, s[36:39], s58 offen nt lds
    s_add_u32 s58, s58, 1024
    s_add_u32 s59, s59, 1024
    s_mov_b32 m0, s59
    s_nop 0
    buffer_load_dwordx4 v27, s[36:39], s58 offen nt lds
    s_add_u32 s58, s58, 1024
    s_add_u32 s59, s59, 1024
    s_mov_b32 m0, s59
    s_nop 0
    buffer_load_dwordx4 v27, s[36:39], s58 offen nt lds
    s_add_u32 s58, s58, 1024
    s_add_u32 s59, s59, 1024
    s_mov_b32 m0, s59
    s_nop 0
    buffer_load_dwordx4 v27, s[36:39], s58 offen nt lds
    s_add_u32 s58, s58, 1024
    s_add_u32 s59, s59, 1024
    s_mov_b32 m0, s59
    s_nop 0
    buffer_load_dwordx4 v27, s[36:39], s58 offen nt lds
    s_add_u32 s58, s58, 1024
    s_add_u32 s59, s59, 1024
    s_mov_b32 m0, s59
    s_nop 0
    buffer_load_dwordx4 v27, s[36:39], s58 offen nt lds
    s_add_u32 s58, s58, 1024
    s_add_u32 s59, s59, 1024
    s_mov_b32 m0, s59
    s_nop 0
    buffer_load_dwordx4 v27, s[36:39], s58 offen nt lds
    s_add_u32 s58, s58, 1024
    s_add_u32 s59, s59, 1024
    s_waitcnt vmcnt(24)
    s_mov_b64 exec, 1
    ds_add_u32 v9, v10 offset:136
    s_mov_b64 exec, -1
    s_mov_b32 m0, s59
    s_nop 0
    buffer_load_dwordx4 v27, s[36:39], s58 offen nt lds
    s_add_u32 s58, s58, 1024
    s_add_u32 s59, s59, 1024
    s_mov_b32 m0, s59
    s_nop 0
    buffer_load_dwordx4 v27, s[36:39], s58 offen nt lds
    s_add_u32 s58, s58, 1024
    s_add_u32 s59, s59, 1024
    s_mov_b32 m0, s59
    s_nop 0
    buffer_load_dwordx4 v27, s[36:39], s58 offen nt lds
    s_add_u32 s58, s58, 1024
    s_add_u32 s59, s59, 1024
    s_mov_b32 m0, s59
    s_nop 0
    buffer_load_dwordx4 v27, s[36:39], s58 offen nt lds
    s_add_u32 s58, s58, 1024
    s_add_u32 s59, s59, 1024
    s_mov_b32 m0, s59
    s_nop 0
    buffer_load_dwordx4 v27, s[36:39], s58 offen nt lds
    s_add_u32 s58, s58, 1024
    s_add_u32 s59, s59, 1024
    s_mov_b32 m0, s59
    s_nop 0
    buffer_load_dwordx4 v27, s[36:39], s58 offen nt lds
    s_add_u32 s58, s58, 1024
    s_add_u32 s59, s59, 1024
    s_mov_b32 m0, s59
    s_nop 0
    buffer_load_dwordx4 v27, s[36:39], s58 offen nt lds
    s_add_u32 s58, s58, 1024
    s_add_u32 s59, s59, 1024
    s_mov_b32 m0, s59
    s_nop 0
    buffer_load_dwordx4 v27, s[36:39], s58 offen nt lds
    s_add_u32 s58, s58, 1024
    s_add_u32 s59, s59, 1024
    s_mov_b32 m0, s59
    s_nop 0
    buffer_load_dwordx4 v27, s[36:39], s58 offen nt lds
    s_add_u32 s58, s58, 1024
    s_add_u32 s59, s59, 1024
    s_mov_b32 m0, s59
    s_nop 0
    buffer_load_dwordx4 v27, s[36:39], s58 offen nt lds
    s_add_u32 s58, s58, 1024
    s_add_u32 s59, s59, 1024
    s_mov_b32 m0, s59
    s_nop 0
    buffer_load_dwordx4 v27, s[36:39], s58 offen nt lds
    s_add_u32 s58, s58, 1024
    s_add_u32 s59, s59, 1024
    s_mov_b32 m0, s59
    s_nop 0
    buffer_load_dwordx4 v27, s[36:39], s58 offen nt lds
L_ffn_dd:
    v_cmp_eq_u32 s[56:57], 1, v5
    v_cmp_eq_u32 s[58:59], 2, v5
    v_cmp_eq_u32 s[60:61], 3, v5
    v_and_b32 v28, 1, v1
    v_mul_u32_u24 v28, 144, v28
    v_lshl_add_u32 v28, v5, 4, v28
    v_lshrrev_b32 v26, 2, v1
    v_mul_u32_u24 v26, 4608, v26
    v_and_b32 v17, 3, v1
    v_lshl_add_u32 v26, v17, 4, v26
    s_lshl_b32 s48, s6, 5
    s_mul_i32 s7, s3, 73728
    s_add_u32 s48, s48, s7
    s_add_u32 s48, s48, 65536
    s_add_u32 s49, s48, 73728
    v_lshrrev_b32 v19, 5, v1
    v_mul_u32_u24 v29, 1152, v19
    v_lshl_add_u32 v29, v17, 2, v29
    v_mul_u32_u24 v25, 1344, v19
    v_lshl_add_u32 v25, v17, 2, v25
    s_lshl_b32 s7, s6, 3
    v_add_u32 v25, s7, v25
    s_cmp_eq_u32 s3, 2
    s_cbranch_scc1 L_ffn_w2
    s_cmp_lg_u32 s3, 7
    s_cbranch_scc1 L_ffn_w2
    v_mov_b32 v64, 0x3f803f80
    v_mov_b32 v65, 0x3f803f80
    v_mov_b32 v66, 0x3f803f80
    v_mov_b32 v67, 0x3f803f80
    ds_write_b128 v27, v[64:67] offset:3456
    s_mov_b64 exec, 0xffff
    ds_write_b128 v27, v[64:67] offset:4480
    s_mov_b64 exec, -1
L_ffn_w2:
    s_cmp_ge_u32 s3, 4
    s_cbranch_scc1 L_ffn_nob
    v_lshrrev_b32 v16, 2, v6
    v_lshl_add_u32 v16, v5, 3, v16
    v_lshlrev_b32 v16, 6, v16
    v_and_b32 v17, 1, v1
    v_lshl_add_u32 v16, v17, 3, v16
    v_bfe_u32 v17, v1, 1, 1
    v_mul_u32_u24 v17, 36896, v17
    v_add_u32 v16, v16, v17
    v_and_b32 v17, 1, v5
    v_xor_b32 v17, s3, v17
    v_lshl_add_u32 v16, v17, 4, v16
    v_add_u32 v16, 25088, v16
    v_mul_u32_u24 v12, 144, v5
    v_lshl_add_u32 v12, v6, 1, v12
    s_lshl_b32 s7, s3, 4
    v_add_u32 v12, s7, v12
    v_and_b32 v15, 3, v1
    v_min_u32 v15, 2, v15
    v_mul_u32_u24 v15, 1344, v15
    v_lshl_add_u32 v15, v5, 4, v15
    v_add_u32 v15, 768, v15
    v_lshrrev_b32 v17, 2, v6
    v_mul_u32_u24 v24, 320, v17
    v_add_u32 v24, v24, v15
    v_cmp_eq_u32 s[46:47], v17, v5
    v_and_b32 v17, 1, v1
    v_cmp_eq_u32 s[50:51], 1, v17
    v_and_b32 v17, 1, v5
    v_cmp_eq_u32 s[52:53], 1, v17
    s_mov_b32 s62, 4194304
L_cw_26:
    ds_read_b32 v31, v9 offset:136
    s_waitcnt lgkmcnt(0)
    v_readfirstlane_b32 s7, v31
    s_cmp_ge_u32 s7, 1
    s_cbranch_scc1 L_cd_27
    s_sleep 1
    s_sub_u32 s62, s62, 1
    s_cmp_lg_u32 s62, 0
    s_cbranch_scc1 L_cw_26
L_cd_27:
    ds_read_b64_tr_b16 v[184:185], v16 offset:0
    ds_read_b64_tr_b16 v[186:187], v16 offset:256
    ds_read_b64_tr_b16 v[188:189], v16 offset:2048
    ds_read_b64_tr_b16 v[190:191], v16 offset:2304
    ds_read_b64_tr_b16 v[192:193], v16 offset:4096
    ds_read_b64_tr_b16 v[194:195], v16 offset:4352
    ds_read_b64_tr_b16 v[196:197], v16 offset:6144
    ds_read_b64_tr_b16 v[198:199], v16 offset:6400
    ds_read_b64_tr_b16 v[200:201], v16 offset:8192
    ds_read_b64_tr_b16 v[202:203], v16 offset:8448
    ds_read_b64_tr_b16 v[204:205], v16 offset:10240
    ds_read_b64_tr_b16 v[206:207], v16 offset:10496
    ds_read_b64_tr_b16 v[208:209], v16 offset:12288
    ds_read_b64_tr_b16 v[210:211], v16 offset:12544
    ds_read_b64_tr_b16 v[212:213], v16 offset:14336
    ds_read_b64_tr_b16 v[214:215], v16 offset:14592
    ds_read_b64_tr_b16 v[216:217], v16 offset:16384
    ds_read_b64_tr_b16 v[218:219], v16 offset:16640
    ds_read_b64_tr_b16 v[220:221], v16 offset:18432
    ds_read_b64_tr_b16 v[222:223], v16 offset:18688
    ds_read_b64_tr_b16 v[224:225], v16 offset:20480
    ds_read_b64_tr_b16 v[226:227], v16 offset:20736
    ds_read_b64_tr_b16 v[228:229], v16 offset:22528
    ds_read_b64_tr_b16 v[230:231], v16 offset:22784
    ds_read_b64_tr_b16 v[232:233], v16 offset:24576
    ds_read_b64_tr_b16 v[234:235], v16 offset:24832
    ds_read_b64_tr_b16 v[236:237], v16 offset:26624
    ds_read_b64_tr_b16 v[238:239], v16 offset:26880
    ds_read_b64_tr_b16 v[240:241], v16 offset:28672
    ds_read_b64_tr_b16 v[242:243], v16 offset:28928
    ds_read_b64_tr_b16 v[244:245], v16 offset:30720
    ds_read_b64_tr_b16 v[246:247], v16 offset:30976
    ds_read_b64_tr_b16 v[248:249], v16 offset:32768
    ds_read_b64_tr_b16 v[250:251], v16 offset:33024
    ds_read_b64_tr_b16 v[252:253], v16 offset:34816
    ds_read_b64_tr_b16 v[254:255], v16 offset:35072
L_ffn_nob:
    s_cmp_lt_u32 s3, 4
    s_cbranch_scc1 L_ffn_hb
    v_lshrrev_b32 v17, 2, v6
    v_lshl_add_u32 v16, v5, 3, v17
    v_mul_u32_u24 v16, 1152, v16
    v_and_b32 v17, 3, v1
    v_lshl_add_u32 v16, v17, 3, v16
    s_sub_u32 s63, s3, 4
    s_mul_i32 s7, s63, 288
    s_add_u32 s7, s7, 99072
    v_add_u32 v16, s7, v16
    s_mul_i32 s54, s6, 4608
    s_mul_i32 s7, s63, 1152
    s_add_u32 s54, s54, s7
    s_add_u32 s54, s54, 65536
    s_sub_u32 s7, s3, 4
    s_lshl_b32 s45, s7, 10
    s_add_u32 s45, s45, s44
    s_lshl_b32 s7, s7, 8
    v_lshlrev_b32 v24, 2, v1
    v_add_u32 v24, s7, v24
    v_mov_b32 v148, 0
    v_mov_b32 v149, s4
    v_mov_b32 v150, 0
    v_mov_b32 v151, s4
    s_cmp_eq_u32 s3, 7
    s_cbranch_scc1 L_h3_two
    s_mov_b32 s62, 262144
    s_mov_b64 s[64:65], -1
    s_mov_b64 exec, -1
L_poll_28:
    s_mov_b64 exec, s[64:65]
    buffer_load_dwordx4 v[144:147], v27, s[16:19], s45 offen offset:0 sc1
    s_mov_b64 exec, -1
    s_waitcnt vmcnt(0)
L_pchk_30:
    v_xor_b32 v30, s4, v145
    v_bitop3_b32 v30, v30, v147, s4 bitop3:0xf6
    v_cmp_ne_u32 s[64:65], 0, v30
    s_cmp_lg_u64 s[64:65], 0
    s_cbranch_scc0 L_pdone_29
    s_sleep 1
    s_sub_u32 s62, s62, 1
    s_cmp_lg_u32 s62, 0
    s_cbranch_scc1 L_poll_28
L_pdone_29:
    s_branch L_h3_w
L_h3_two:
    s_mov_b32 s62, 262144
    s_mov_b64 s[64:65], -1
    s_mov_b32 s66, -1
    s_mov_b32 s67, 0
    s_mov_b64 exec, -1
L_poll_31:
    s_mov_b64 exec, s[64:65]
    buffer_load_dwordx4 v[144:147], v27, s[16:19], s45 offen offset:0 sc1
    s_mov_b64 exec, s[66:67]
    buffer_load_dwordx4 v[148:151], v27, s[16:19], s45 offen offset:1024 sc1
    s_mov_b64 exec, -1
    s_waitcnt vmcnt(0)
L_pchk_33:
    v_xor_b32 v30, s4, v145
    v_bitop3_b32 v30, v30, v147, s4 bitop3:0xf6
    v_cmp_ne_u32 s[64:65], 0, v30
    v_xor_b32 v31, s4, v149
    v_bitop3_b32 v31, v31, v151, s4 bitop3:0xf6
    v_cmp_ne_u32 s[66:67], 0, v31
    s_or_b64 vcc, s[64:65], s[66:67]
    s_cbranch_scc0 L_pdone_32
    s_sleep 1
    s_sub_u32 s62, s62, 1
    s_cmp_lg_u32 s62, 0
    s_cbranch_scc1 L_poll_31
L_pdone_32:
    ds_write_b32 v24, v148 offset:1024
    ds_write_b32 v24, v150 offset:2368
L_h3_w:
    ds_write_b32 v24, v144 offset:768
    ds_write_b32 v24, v146 offset:2112
L_ffn_hb:
    s_add_u32 s4, s4, 1
    v_mov_b32 v21, s4
    v_mov_b32 v23, s4
    v_mov_b32 v61, s4
    s_cmp_lt_u32 s3, 4
    s_cbranch_scc1 L_ffn_mm
    s_waitcnt lgkmcnt(0)
    s_barrier
    s_sleep 2
    ds_read_b64_tr_b16 v[160:161], v16 offset:0
    ds_read_b64_tr_b16 v[162:163], v16 offset:4608
    ds_read_b64_tr_b16 v[164:165], v16 offset:32
    ds_read_b64_tr_b16 v[166:167], v16 offset:4640
    ds_read_b64_tr_b16 v[168:169], v16 offset:64
    ds_read_b64_tr_b16 v[170:171], v16 offset:4672
    ds_read_b64_tr_b16 v[172:173], v16 offset:96
    ds_read_b64_tr_b16 v[174:175], v16 offset:4704
    ds_read_b64_tr_b16 v[176:177], v16 offset:128
    ds_read_b64_tr_b16 v[178:179], v16 offset:4736
    ds_read_b64_tr_b16 v[180:181], v16 offset:160
    ds_read_b64_tr_b16 v[182:183], v16 offset:4768
    ds_read_b64_tr_b16 v[184:185], v16 offset:192
    ds_read_b64_tr_b16 v[186:187], v16 offset:4800
    ds_read_b64_tr_b16 v[188:189], v16 offset:224
    ds_read_b64_tr_b16 v[190:191], v16 offset:4832
    ds_read_b64_tr_b16 v[192:193], v16 offset:256
    ds_read_b64_tr_b16 v[194:195], v16 offset:4864
    s_waitcnt lgkmcnt(0)
    s_barrier
    ds_read_b128 v[32:35], v28 offset:256
    s_waitcnt lgkmcnt(0)
    v_mfma_f32_16x16x32_bf16 v[64:67], v[32:35], v[160:163], 0
    v_mfma_f32_16x16x32_bf16 v[68:71], v[32:35], v[164:167], 0
    v_mfma_f32_16x16x32_bf16 v[72:75], v[32:35], v[168:171], 0
    v_mfma_f32_16x16x32_bf16 v[76:79], v[32:35], v[172:175], 0
    v_mfma_f32_16x16x32_bf16 v[80:83], v[32:35], v[176:179], 0
    v_mfma_f32_16x16x32_bf16 v[84:87], v[32:35], v[180:183], 0
    v_mfma_f32_16x16x32_bf16 v[88:91], v[32:35], v[184:187], 0
    v_mfma_f32_16x16x32_bf16 v[92:95], v[32:35], v[188:191], 0
    v_mfma_f32_16x16x32_bf16 v[96:99], v[32:35], v[192:195], 0
    v_cvt_pk_bf16_f32 v64, v64, v65
    v_cvt_pk_bf16_f32 v68, v68, v69
    v_cvt_pk_bf16_f32 v72, v72, v73
    v_cvt_pk_bf16_f32 v76, v76, v77
    v_cndmask_b32 v20, v64, v68, s[56:57]
    v_cndmask_b32 v20, v20, v72, s[58:59]
    v_cndmask_b32 v20, v20, v76, s[60:61]
    buffer_store_dwordx2 v[20:21], v11, s[16:19], s54 offen offset:0 sc1
    v_cvt_pk_bf16_f32 v80, v80, v81
    v_cvt_pk_bf16_f32 v84, v84, v85
    v_cvt_pk_bf16_f32 v88, v88, v89
    v_cvt_pk_bf16_f32 v92, v92, v93
    v_cndmask_b32 v22, v80, v84, s[56:57]
    v_cndmask_b32 v22, v22, v88, s[58:59]
    v_cndmask_b32 v22, v22, v92, s[60:61]
    buffer_store_dwordx2 v[22:23], v11, s[16:19], s54 offen offset:512 sc1
    v_cvt_pk_bf16_f32 v60, v96, v97
    s_mov_b64 exec, 0xffff
    buffer_store_dwordx2 v[60:61], v11, s[16:19], s54 offen offset:1024 sc1
    s_mov_b64 exec, -1
    s_branch L_ffn_h4
L_ffn_mm:
    v_mov_b32 v32, 0x3f803f80
    v_mov_b32 v33, 0x3f803f80
    v_mov_b32 v34, 0x3f803f80
    v_mov_b32 v35, 0x3f803f80
    s_waitcnt lgkmcnt(0)
    s_nop 0
    v_mfma_f32_16x16x32_bf16 v[56:59], v[32:35], v[184:187], 0
    v_mfma_f32_16x16x32_bf16 v[56:59], v[32:35], v[188:191], v[56:59]
    v_mfma_f32_16x16x32_bf16 v[56:59], v[32:35], v[192:195], v[56:59]
    v_mfma_f32_16x16x32_bf16 v[56:59], v[32:35], v[196:199], v[56:59]
    v_mfma_f32_16x16x32_bf16 v[56:59], v[32:35], v[200:203], v[56:59]
    v_mfma_f32_16x16x32_bf16 v[56:59], v[32:35], v[204:207], v[56:59]
    v_mfma_f32_16x16x32_bf16 v[56:59], v[32:35], v[208:211], v[56:59]
    v_mfma_f32_16x16x32_bf16 v[56:59], v[32:35], v[212:215], v[56:59]
    v_mfma_f32_16x16x32_bf16 v[56:59], v[32:35], v[216:219], v[56:59]
    v_mfma_f32_16x16x32_bf16 v[56:59], v[32:35], v[220:223], v[56:59]
    v_mfma_f32_16x16x32_bf16 v[56:59], v[32:35], v[224:227], v[56:59]
    v_mfma_f32_16x16x32_bf16 v[56:59], v[32:35], v[228:231], v[56:59]
    v_mfma_f32_16x16x32_bf16 v[56:59], v[32:35], v[232:235], v[56:59]
    v_mfma_f32_16x16x32_bf16 v[56:59], v[32:35], v[236:239], v[56:59]
    v_mfma_f32_16x16x32_bf16 v[56:59], v[32:35], v[240:243], v[56:59]
    v_mfma_f32_16x16x32_bf16 v[56:59], v[32:35], v[244:247], v[56:59]
    v_mfma_f32_16x16x32_bf16 v[56:59], v[32:35], v[248:251], v[56:59]
    v_mfma_f32_16x16x32_bf16 v[56:59], v[32:35], v[252:255], v[56:59]
    s_waitcnt vmcnt(0)
    s_barrier
    ds_read_b128 v[160:163], v24 offset:0
    ds_read_b128 v[164:167], v24 offset:64
    ds_read_b128 v[168:171], v24 offset:128
    ds_read_b128 v[172:175], v24 offset:192
    ds_read_b128 v[176:179], v24 offset:256
    s_waitcnt lgkmcnt(4)
    v_mfma_f32_16x16x32_bf16 v[44:47], v[160:163], v[160:163], 0
    s_waitcnt lgkmcnt(3)
    v_mfma_f32_16x16x32_bf16 v[44:47], v[164:167], v[164:167], v[44:47]
    s_waitcnt lgkmcnt(2)
    v_mfma_f32_16x16x32_bf16 v[44:47], v[168:171], v[168:171], v[44:47]
    s_waitcnt lgkmcnt(1)
    v_mfma_f32_16x16x32_bf16 v[44:47], v[172:175], v[172:175], v[44:47]
    s_waitcnt lgkmcnt(0)
    v_mfma_f32_16x16x32_bf16 v[44:47], v[176:179], v[176:179], v[44:47]
    v_mfma_f32_16x16x32_bf16 v[64:67], v[160:163], v[184:187], 0
    v_mfma_f32_16x16x32_bf16 v[64:67], v[164:167], v[188:191], v[64:67]
    v_mfma_f32_16x16x32_bf16 v[64:67], v[168:171], v[192:195], v[64:67]
    v_mfma_f32_16x16x32_bf16 v[64:67], v[172:175], v[196:199], v[64:67]
    v_mfma_f32_16x16x32_bf16 v[64:67], v[176:179], v[200:203], v[64:67]
    s_nop 2
    v_cndmask_b32 v48, v44, v45, s[50:51]
    v_cndmask_b32 v49, 0, v46, s[46:47]
    v_mfma_f32_16x16x32_bf16 v[68:71], v[160:163], v[204:207], 0
    v_cndmask_b32 v48, 0, v48, s[46:47]
    v_add_f32_dpp v49, v49, v49 row_ror:4 row_mask:0xf bank_mask:0xf
    v_mfma_f32_16x16x32_bf16 v[68:71], v[164:167], v[208:211], v[68:71]
    v_add_f32_dpp v48, v48, v48 row_ror:4 row_mask:0xf bank_mask:0xf
    v_add_f32_dpp v49, v49, v49 row_ror:8 row_mask:0xf bank_mask:0xf
    v_mfma_f32_16x16x32_bf16 v[68:71], v[168:171], v[212:215], v[68:71]
    v_add_f32_dpp v48, v48, v48 row_ror:8 row_mask:0xf bank_mask:0xf
    v_mov_b32 v52, 0x3d372713
    s_nop 0
    v_permlane16_swap_b32 v48, v49
    v_mfma_f32_16x16x32_bf16 v[68:71], v[172:175], v[216:219], v[68:71]
    v_add_f32 v48, v48, v49
    v_mov_b32 v49, v48
    v_mov_b32 v53, 0x3ae38e39
    v_mfma_f32_16x16x32_bf16 v[68:71], v[176:179], v[220:223], v[68:71]
    v_permlane32_swap_b32 v48, v49
    v_add_f32 v48, v48, v49
    v_mul_f32 v48, v48, v53
    v_mfma_f32_16x16x32_bf16 v[72:75], v[160:163], v[224:227], 0
    v_mov_b32 v49, v48
    s_nop 0
    s_nop 0
    v_permlane16_swap_b32 v48, v49
    v_mfma_f32_16x16x32_bf16 v[72:75], v[164:167], v[228:231], v[72:75]
    v_fma_f32 v48, -v49, v49, v48
    v_max_f32 v48, 0, v48
    v_cvt_pk_bf16_f32 v48, v49, v48
    v_mfma_f32_16x16x32_bf16 v[72:75], v[168:171], v[232:235], v[72:75]
    v_lshlrev_b32 v49, 16, v48
    v_and_b32 v48, 0xffff0000, v48
    v_add_f32 v48, 0x3727c5ac, v48
    v_mfma_f32_16x16x32_bf16 v[72:75], v[172:175], v[236:239], v[72:75]
    v_cndmask_b32 v40, v64, v68, s[56:57]
    v_cndmask_b32 v41, v65, v69, s[56:57]
    v_mfma_f32_16x16x32_bf16 v[72:75], v[176:179], v[240:243], v[72:75]
    v_cvt_pk_bf16_f32 v48, v48, v48
    v_lshlrev_b32 v48, 16, v48
    v_sqrt_f32 v48, v48
    v_mfma_f32_16x16x32_bf16 v[76:79], v[160:163], v[244:247], 0
    v_mov_b32_dpp v50, v49 quad_perm:[0,0,0,0] row_mask:0x5 bank_mask:0xf
    v_cvt_pk_bf16_f32 v48, v48, v48
    v_lshlrev_b32 v48, 16, v48
    v_mfma_f32_16x16x32_bf16 v[76:79], v[164:167], v[248:251], v[76:79]
    v_rcp_f32 v48, v48
    v_mov_b32_dpp v50, v49 quad_perm:[1,1,1,1] row_mask:0xa bank_mask:0xf
    s_nop 0
    v_mov_b32_dpp v51, v48 quad_perm:[0,0,0,0] row_mask:0x5 bank_mask:0xf
    v_mfma_f32_16x16x32_bf16 v[76:79], v[168:171], v[252:255], v[76:79]
    s_nop 0
    v_mov_b32_dpp v51, v48 quad_perm:[1,1,1,1] row_mask:0xa bank_mask:0xf
    v_cndmask_b32 v40, v40, v72, s[58:59]
    v_cndmask_b32 v41, v41, v73, s[58:59]
    s_nop 3
    v_cndmask_b32 v40, v40, v76, s[60:61]
    v_cndmask_b32 v41, v41, v77, s[60:61]
    s_nop 1
    v_permlane16_swap_b32 v40, v41
    v_add_f32 v40, v40, v41
    v_mov_b32 v41, v40
    s_nop 1
    v_permlane32_swap_b32 v40, v41
    v_add_f32 v40, v40, v41
    v_fma_f32 v40, -v50, v56, v40
    v_mul_f32 v40, v40, v51
    v_mul_f32 v41, v40, v40
    v_mul_f32 v44, 0xc0135761, v40
    v_fma_f32 v41, v41, v52, 1.0
    v_mov_b32_dpp v43, v40 row_ror:8 row_mask:0xf bank_mask:0xf
    v_mul_f32 v41, v41, v44
    v_exp_f32 v41, v41
    v_mul_f32 v43, v43, v40
    v_add_f32 v41, 1.0, v41
    v_rcp_f32 v41, v41
    s_nop 0
    v_mul_f32 v41, v41, v43
    v_cvt_pk_bf16_f32 v41, v41, v41
    s_mov_b64 exec, 0x00ff00ff
    ds_write_b16 v12, v41 offset:256
    s_mov_b64 exec, -1
    s_waitcnt lgkmcnt(0)
    s_barrier
    ds_read_b32 v14, v25 offset:768
    s_sleep 6
L_ffn_h4:
    s_bitcmp1_b32 s6, 0
    s_cbranch_scc1 L_fin
    s_lshr_b32 s7, s3, 1
    s_lshl_b32 s7, s7, 10
    s_and_b32 s63, s3, 1
    s_lshl_b32 s63, s63, 3
    s_add_u32 s7, s7, s63
    s_add_u32 s7, s7, 16128
    v_add_u32 v13, s7, v27
    v_bfe_u32 v100, v1, 3, 1
    v_lshlrev_b32 v100, 4, v100
    v_mov_b32 v101, 0x3f80
    v_lshlrev_b32 v101, v100, v101
    v_and_b32 v100, 1, v1
    v_cmp_eq_u32 vcc, 1, v100
    s_nop 1
    v_cndmask_b32 v100, v101, 0, vcc
    v_cndmask_b32 v101, 0, v101, vcc
    v_mov_b32 v102, v100
    v_mov_b32 v103, v101
    s_sleep 10
    s_cmp_eq_u32 s3, 7
    s_cbranch_scc1 L_h4_two
    s_mov_b32 s62, 262144
    s_mov_b64 s[64:65], -1
    s_mov_b64 exec, -1
L_poll_34:
    s_mov_b64 exec, s[64:65]
    buffer_load_dwordx4 v[136:139], v26, s[16:19], s48 offen sc1
    s_mov_b64 exec, -1
    s_waitcnt vmcnt(0)
L_pchk_36:
    v_xor_b32 v30, s4, v137
    v_bitop3_b32 v30, v30, v139, s4 bitop3:0xf6
    v_cmp_ne_u32 s[64:65], 0, v30
    s_cmp_lg_u64 s[64:65], 0
    s_cbranch_scc0 L_pdone_35
    s_sub_u32 s62, s62, 1
    s_cmp_lg_u32 s62, 0
    s_cbranch_scc1 L_poll_34
L_pdone_35:
    s_branch L_h4_w
L_h4_two:
    v_mov_b32 v145, 0
    v_mov_b32 v146, 0
    v_mov_b32 v147, 0
    s_mov_b32 s62, 262144
    s_mov_b64 s[64:65], -1
    s_mov_b64 s[66:67], -1
    s_mov_b64 exec, -1
L_poll_37:
    s_mov_b64 exec, s[64:65]
    buffer_load_dwordx4 v[136:139], v26, s[16:19], s48 offen sc1
    s_mov_b64 exec, s[66:67]
    buffer_load_dwordx4 v[140:143], v26, s[16:19], s49 offen sc1
    s_mov_b64 exec, -1
    s_waitcnt vmcnt(0)
L_pchk_39:
    v_xor_b32 v30, s4, v137
    v_bitop3_b32 v30, v30, v139, s4 bitop3:0xf6
    v_cmp_ne_u32 s[64:65], 0, v30
    v_xor_b32 v31, s4, v141
    v_bitop3_b32 v31, v31, v143, s4 bitop3:0xf6
    v_cmp_ne_u32 s[66:67], 0, v31
    s_or_b64 vcc, s[64:65], s[66:67]
    s_cbranch_scc0 L_pdone_38
    s_sub_u32 s62, s62, 1
    s_cmp_lg_u32 s62, 0
    s_cbranch_scc1 L_poll_37
L_pdone_38:
    v_mov_b32 v144, v140
    v_mov_b32 v145, v142
    ds_write_b128 v27, v[144:147] offset:20224
L_h4_w:
    ds_write2_b32 v13, v136, v138 offset0:0 offset1:1
    s_waitcnt lgkmcnt(0)
    s_barrier
    s_cmp_lg_u32 s3, 0
    s_cbranch_scc1 L_fin
    ds_read_b128 v[68:71], v27 offset:16128
    ds_read_b128 v[72:75], v27 offset:17152
    ds_read_b128 v[76:79], v27 offset:18176
    ds_read_b128 v[80:83], v27 offset:19200
    ds_read_b128 v[84:87], v27 offset:20224
    v_lshlrev_b32 v98, 16, v14
    v_and_b32 v99, 0xffff0000, v14
    s_waitcnt lgkmcnt(4)
    v_mfma_f32_16x16x32_bf16 v[64:67], v[100:103], v[68:71], 0
    s_waitcnt lgkmcnt(3)
    v_mfma_f32_16x16x32_bf16 v[64:67], v[100:103], v[72:75], v[64:67]
    s_waitcnt lgkmcnt(2)
    v_mfma_f32_16x16x32_bf16 v[64:67], v[100:103], v[76:79], v[64:67]
    s_waitcnt lgkmcnt(1)
    v_mfma_f32_16x16x32_bf16 v[64:67], v[100:103], v[80:83], v[64:67]
    s_waitcnt lgkmcnt(0)
    v_mfma_f32_16x16x32_bf16 v[64:67], v[100:103], v[84:87], v[64:67]
    s_nop 7
    v_add_f32_dpp v64, v64, v64 row_ror:8 row_mask:0xf bank_mask:0xf
    v_add_f32_dpp v65, v65, v65 row_ror:8 row_mask:0xf bank_mask:0xf
    s_nop 0
    v_add_f32_dpp v64, v64, v64 row_ror:4 row_mask:0xf bank_mask:0xf
    v_add_f32_dpp v65, v65, v65 row_ror:4 row_mask:0xf bank_mask:0xf
    v_cvt_pk_bf16_f32 v64, v64, v65
    v_lshlrev_b32 v96, 16, v64
    v_and_b32 v97, 0xffff0000, v64
    v_add_f32 v96, v96, v98
    v_add_f32 v97, v97, v99
    v_cvt_pk_bf16_f32 v20, v96, v97
    s_lshl_b32 s7, s6, 3
    s_mov_b32 exec_lo, 15
    s_mov_b32 exec_hi, 15
    buffer_store_dword v20, v29, s[40:43], s7 offen
    s_mov_b64 exec, -1
    s_cmp_lg_u32 s6, 0
    s_cbranch_scc1 L_fin
    v_mov_b32 v20, s4
    v_mov_b32 v18, 0
    s_mov_b64 exec, 1
    buffer_store_dword v20, v18, s[16:19], 0 offen sc1
    s_mov_b64 exec, -1
L_fin:
L_end:
    s_endpgm
.fill 1024, 4, 0xbf810000
.section .rodata,"a"
.p2align 6
.amdhsa_kernel sequential_preLN__gqa_block_cached__geglu_ffn__decode_kernel
.amdhsa_next_free_vgpr 256
.amdhsa_next_free_sgpr 102
.amdhsa_accum_offset 256
.amdhsa_group_segment_fixed_size 0
.amdhsa_kernarg_size 96
.amdhsa_user_sgpr_count 2
.amdhsa_user_sgpr_kernarg_segment_ptr 1
.amdhsa_system_sgpr_workgroup_id_x 1
.amdhsa_float_denorm_mode_32 3
.amdhsa_float_denorm_mode_16_64 3
.end_amdhsa_kernel
```
